```python
import torch

def _softmax(x, axis=-1):
    return torch.softmax(x, dim=axis)
def _gelu(x):
    return torch.nn.functional.gelu(x, approximate="tanh")
def _silu(x):
    return torch.nn.functional.silu(x)
def _sigmoid(x):
    return torch.sigmoid(x)
def _layernorm(x, axis=-1, eps=1e-5):
    m = x.mean(dim=axis, keepdim=True)
    v = x.var(dim=axis, keepdim=True, unbiased=False)
    return (x - m) / torch.sqrt(v + eps)
def _scatter_add(tgt, idx, src, axis=0):
    return tgt.clone().index_add_(axis, idx, src)
def _segment_sum(src, seg, n):
    out = torch.zeros((n,) + src.shape[1:], dtype=src.dtype)
    return out.index_add_(0, seg, src)
def _pad(x, pw):
    flat = tuple(v for pair in reversed(pw) for v in pair)
    return torch.nn.functional.pad(x, flat)

kernel_name = 'standalone__mha_softmax__near_ridge'

def setup_inputs():

    _w = (lambda a: (lambda t: t.to(torch.bfloat16) if t.is_floating_point() else t)(torch.as_tensor(a)))
    B, H, Sq, Sk, D = 16, 32, 512, 512, 128
    return {
        "q": _w((lambda *s: torch.randn(*s, dtype=torch.bfloat16) * 0.8)(B, H, Sq, D)),
        "k": _w((lambda *s: torch.randn(*s, dtype=torch.bfloat16) * 0.8)(B, H, Sk, D)),
        "v": _w((lambda *s: torch.randn(*s, dtype=torch.bfloat16) * 0.05)(B, H, Sk, D)),
    }

def reference(q, k, v):
    scale = q.shape[-1] ** -0.5
    scores = torch.einsum("bhqd,bhkd->bhqk", q, k) * scale
    p = _softmax(scores, axis=-1)
    return torch.einsum("bhqk,bhkd->bhqd", p, v)
```

```asm
; @launch grid=(256,1,1) block=(256,1,1) lds=163840
.amdgcn_target "amdgcn-amd-amdhsa--gfx950"
.text
.globl standalone__mha_softmax__near_ridge_kernel
.p2align 8
.type standalone__mha_softmax__near_ridge_kernel,@function
standalone__mha_softmax__near_ridge_kernel:
  s_cmp_ge_u32 s2, 256
  s_cbranch_scc1 L_end
  s_load_dwordx4 s[36:39], s[0:1], 0
  s_load_dwordx4 s[40:43], s[0:1], 16
  v_lshrrev_b32 v1, 6, v0
  v_and_b32 v0, 63, v0
  v_readfirstlane_b32 s20, v1
  v_lshrrev_b32 v2, 4, v0
  v_and_b32 v3, 15, v0
  s_and_b32 s45, s2, 7
  s_lshr_b32 s46, s2, 4
  s_lshl_b32 s45, s45, 4
  s_add_u32 s45, s45, s46
  s_mul_i32 s55, s45, 10240
  s_and_b32 s55, s55, 32767
  s_mov_b32 s56, s55
  s_mul_i32 s82, s45, 6144
  s_lshl_b32 s45, s45, 17
  s_bfe_u32 s46, s2, 0x10003
  s_lshl_b32 s46, s46, 16
  s_add_u32 s46, s46, s45
  s_lshl_b32 s23, s20, 11
  v_lshlrev_b32 v4, 1, v2
  v_xor_b32 v4, v3, v4
  v_lshlrev_b32 v4, 4, v4
  v_lshl_add_u32 v28, v2, 8, v4
  v_xor_b32 v29, 0x80, v28
  s_mov_b32 s29, s23
  s_mov_b32 s49, s23
  s_lshr_b32 s54, s2, 3
  s_lshl_b32 s54, s54, 2
  s_add_u32 s54, s54, s20
  s_and_b32 s54, s54, 31
  s_lshl_b32 s54, s54, 10
  s_min_u32 s54, s54, L_end - L_pc - 1024
  v_lshlrev_b32 v5, 4, v0
  v_add_u32 v5, s54, v5
  s_getpc_b64 s[58:59]
L_pc:
  global_load_dwordx4 v[72:75], v5, s[58:59]
  s_lshl_b32 s44, s20, 13
  s_add_u32 s44, s44, 131072
  s_lshl_b32 s25, s20, 14
  s_add_u32 s64, s82, 0
  s_and_b32 s64, s64, 16383
  s_add_u32 s64, s64, s25
  s_add_u32 s65, s82, 2048
  s_and_b32 s65, s65, 16383
  s_add_u32 s65, s65, s25
  s_add_u32 s66, s82, 4096
  s_and_b32 s66, s66, 16383
  s_add_u32 s66, s66, s25
  s_add_u32 s67, s82, 6144
  s_and_b32 s67, s67, 16383
  s_add_u32 s67, s67, s25
  s_add_u32 s68, s82, 8192
  s_and_b32 s68, s68, 16383
  s_add_u32 s68, s68, s25
  s_add_u32 s69, s82, 10240
  s_and_b32 s69, s69, 16383
  s_add_u32 s69, s69, s25
  s_add_u32 s70, s82, 12288
  s_and_b32 s70, s70, 16383
  s_add_u32 s70, s70, s25
  s_add_u32 s71, s82, 14336
  s_and_b32 s71, s71, 16383
  s_add_u32 s71, s71, s25
  s_mov_b32 s7, 0x20000
  s_mov_b32 s11, 0x20000
  s_mov_b32 s15, 0x20000
  s_mov_b32 s19, 0x20000
  s_mov_b32 s10, 50462720
  s_mov_b32 s14, 50462720
  s_mov_b32 s6, 50397184
  s_mov_b32 s48, 50397184
  s_mov_b32 s18, 0
  s_lshl_b32 s21, s20, 15
  s_mov_b32 s80, s21
  s_mov_b32 s81, s21
  s_add_u32 s21, s21, s55
  s_mov_b32 s22, s21
  s_waitcnt lgkmcnt(0)
  s_add_u32 s8, s38, s45
  s_addc_u32 s9, s39, 0
  s_add_u32 s4, s36, s46
  s_addc_u32 s5, s37, 0
  s_add_u32 s12, s40, s45
  s_addc_u32 s13, s41, 0
  s_add_u32 s16, s42, s46
  s_addc_u32 s17, s43, 0
  s_add_u32 m0, s29, 0
  s_nop 0
  buffer_load_dwordx4 v28, s[8:11], s21 offen offset:0 nt lds
  s_add_u32 m0, s44, 0
  s_nop 0
  buffer_load_dwordx4 v28, s[4:7], s64 offen offset:0 nt lds
  s_add_u32 m0, s49, 65536
  s_nop 0
  buffer_load_dwordx4 v28, s[12:15], s22 offen offset:0 nt lds
  s_add_u32 m0, s29, 0
  s_nop 0
  buffer_load_dwordx4 v29, s[8:11], s21 offen offset:1024 nt lds
  s_add_u32 m0, s49, 65536
  s_nop 0
  buffer_load_dwordx4 v29, s[12:15], s22 offen offset:1024 nt lds
  s_add_u32 s29, s29, 8192
  s_and_b32 s29, s29, 0xffff
  s_add_u32 s55, s55, 2048
  s_and_b32 s55, s55, 32767
  s_add_u32 s21, s80, s55
  s_add_u32 s49, s49, 8192
  s_and_b32 s49, s49, 0xffff
  s_add_u32 s56, s56, 2048
  s_and_b32 s56, s56, 32767
  s_add_u32 s22, s81, s56
  s_add_u32 m0, s44, 0
  s_nop 0
  buffer_load_dwordx4 v29, s[4:7], s64 offen offset:1024 nt lds
  s_add_u32 m0, s44, 2048
  s_nop 0
  buffer_load_dwordx4 v28, s[4:7], s65 offen offset:0 nt lds
  buffer_load_dwordx4 v29, s[4:7], s65 offen offset:1024 nt lds
  s_add_u32 m0, s44, 4096
  s_nop 0
  buffer_load_dwordx4 v28, s[4:7], s66 offen offset:0 nt lds
  buffer_load_dwordx4 v29, s[4:7], s66 offen offset:1024 nt lds
  s_add_u32 m0, s44, 6144
  s_nop 0
  buffer_load_dwordx4 v28, s[4:7], s67 offen offset:0 nt lds
  buffer_load_dwordx4 v29, s[4:7], s67 offen offset:1024 nt lds
  s_sub_u32 s54, s44, 32768
  s_add_u32 m0, s54, 0
  s_nop 0
  buffer_load_dwordx4 v28, s[4:7], s68 offen offset:0 nt lds
  buffer_load_dwordx4 v29, s[4:7], s68 offen offset:1024 nt lds
  s_add_u32 m0, s54, 2048
  s_nop 0
  buffer_load_dwordx4 v28, s[4:7], s69 offen offset:0 nt lds
  buffer_load_dwordx4 v29, s[4:7], s69 offen offset:1024 nt lds
  s_add_u32 m0, s54, 4096
  s_nop 0
  buffer_load_dwordx4 v28, s[4:7], s70 offen offset:0 nt lds
  buffer_load_dwordx4 v29, s[4:7], s70 offen offset:1024 nt lds
  s_add_u32 m0, s54, 6144
  s_nop 0
  buffer_load_dwordx4 v28, s[4:7], s71 offen offset:0 nt lds
  buffer_load_dwordx4 v29, s[4:7], s71 offen offset:1024 nt lds
  s_sub_u32 s72, s64, 16777216
  s_sub_u32 s73, s65, 16777216
  s_sub_u32 s74, s66, 16777216
  s_sub_u32 s75, s67, 16777216
  s_sub_u32 s76, s68, 16777216
  s_sub_u32 s77, s69, 16777216
  s_sub_u32 s78, s70, 16777216
  s_sub_u32 s79, s71, 16777216
  s_add_u32 s64, s64, 16777216
  s_add_u32 s65, s65, 16777216
  s_add_u32 s66, s66, 16777216
  s_add_u32 s67, s67, 16777216
  s_add_u32 s68, s68, 16777216
  s_add_u32 s69, s69, 16777216
  s_add_u32 s70, s70, 16777216
  s_add_u32 s71, s71, 16777216
  v_and_b32 v5, 7, v3
  v_lshlrev_b32 v6, 1, v5
  v_add_u32 v7, 0, v2
  v_xor_b32 v7, v7, v6
  v_lshlrev_b32 v7, 4, v7
  v_lshl_add_u32 v16, v3, 8, v7
  v_add_u32 v30, s44, v16
  v_subrev_u32 v12, 0x8000, v30
  v_add_u32 v7, 4, v2
  v_xor_b32 v7, v7, v6
  v_lshlrev_b32 v7, 4, v7
  v_lshl_add_u32 v17, v3, 8, v7
  v_add_u32 v31, s44, v17
  v_subrev_u32 v13, 0x8000, v31
  v_add_u32 v7, 8, v2
  v_xor_b32 v7, v7, v6
  v_lshlrev_b32 v7, 4, v7
  v_lshl_add_u32 v18, v3, 8, v7
  v_add_u32 v32, s44, v18
  v_subrev_u32 v14, 0x8000, v32
  v_add_u32 v7, 12, v2
  v_xor_b32 v7, v7, v6
  v_lshlrev_b32 v7, 4, v7
  v_lshl_add_u32 v19, v3, 8, v7
  v_add_u32 v33, s44, v19
  v_subrev_u32 v15, 0x8000, v33
  v_lshrrev_b32 v76, 2, v0
  v_and_b32 v77, 7, v76
  v_lshlrev_b32 v77, 1, v77
  v_bfe_u32 v78, v0, 1, 1
  v_and_b32 v79, 1, v0
  v_lshlrev_b32 v79, 3, v79
  v_lshl_add_u32 v79, v76, 8, v79
  v_add_u32 v79, 65536, v79
  v_add_u32 v7, 0, v78
  v_xor_b32 v7, v7, v77
  v_lshl_add_u32 v20, v7, 4, v79
  v_add_u32 v7, 2, v78
  v_xor_b32 v7, v7, v77
  v_lshl_add_u32 v21, v7, 4, v79
  v_add_u32 v7, 4, v78
  v_xor_b32 v7, v7, v77
  v_lshl_add_u32 v22, v7, 4, v79
  v_add_u32 v7, 6, v78
  v_xor_b32 v7, v7, v77
  v_lshl_add_u32 v23, v7, 4, v79
  v_add_u32 v7, 8, v78
  v_xor_b32 v7, v7, v77
  v_lshl_add_u32 v24, v7, 4, v79
  v_add_u32 v7, 10, v78
  v_xor_b32 v7, v7, v77
  v_lshl_add_u32 v25, v7, 4, v79
  v_add_u32 v7, 12, v78
  v_xor_b32 v7, v7, v77
  v_lshl_add_u32 v26, v7, 4, v79
  v_add_u32 v7, 14, v78
  v_xor_b32 v7, v7, v77
  v_lshl_add_u32 v27, v7, 4, v79
  v_lshlrev_b32 v79, 8, v3
  v_add_u32 v79, s44, v79
  v_xor_b32 v78, v2, v5
  v_lshl_add_u32 v34, v78, 4, v79
  v_xor_b32 v35, 64, v34
  v_and_b32 v78, 12, v3
  v_and_b32 v70, 1, v3
  v_lshl_add_u32 v78, v70, 1, v78
  v_xor_b32 v78, v78, v2
  v_lshlrev_b32 v78, 4, v78
  v_lshl_add_u32 v78, v2, 8, v78
  v_and_b32 v70, 2, v3
  v_lshl_add_u32 v78, v70, 2, v78
  v_add_u32 v8, s44, v78
  v_xor_b32 v9, 16, v8
  v_xor_b32 v10, 64, v8
  v_xor_b32 v11, 80, v8
  v_lshlrev_b32 v40, 4, v0
  v_and_b32 v7, 3, v0
  v_cmp_eq_u32 vcc, 0, v7
  v_mov_b32 v76, 0x3f803f80
  v_mov_b32 v77, 0
  v_cndmask_b32 v7, v77, v76, vcc
  v_accvgpr_write_b32 a240, v7
  v_accvgpr_write_b32 a244, v77
  v_accvgpr_write_b32 a241, v7
  v_accvgpr_write_b32 a245, v77
  v_accvgpr_write_b32 a242, v7
  v_accvgpr_write_b32 a246, v77
  v_accvgpr_write_b32 a243, v7
  v_accvgpr_write_b32 a247, v77
  s_mov_b32 s27, 0x3e0293ee
  s_mov_b32 s60, 0x3e0293ee
  s_mov_b32 s61, 0x3e0293ee
  s_mov_b32 s34, 0x2b800000
  s_mov_b32 s35, 0x53000000
  s_mov_b32 s28, 0
  s_mov_b64 s[30:31], 0
  s_mov_b32 s47, 3
  s_mov_b64 vcc, -1
  s_waitcnt vmcnt(8)
  s_barrier
  ds_read_b128 a[96:99], v16 offset:0
  ds_read_b128 a[0:3], v30 offset:0
  ds_read_b128 a[100:103], v17 offset:0
  ds_read_b128 a[4:7], v31 offset:0
  ds_read_b128 a[104:107], v18 offset:0
  ds_read_b128 a[8:11], v32 offset:0
  ds_read_b128 a[108:111], v19 offset:0
  ds_read_b128 a[12:15], v33 offset:0
  ds_read_b128 a[28:31], v33 offset:4096
  ds_read_b128 a[24:27], v32 offset:4096
  ds_read_b128 a[20:23], v31 offset:4096
  ds_read_b128 a[16:19], v30 offset:4096
  ds_read_b128 a[112:115], v16 offset:4096
  ds_read_b128 a[116:119], v17 offset:4096
  ds_read_b128 a[120:123], v18 offset:4096
  ds_read_b128 a[124:127], v19 offset:4096
  s_waitcnt lgkmcnt(14)
  v_mfma_f32_16x16x32_bf16 v[96:99], a[96:99], a[0:3], 0
  s_waitcnt lgkmcnt(12)
  s_add_u32 m0, s29, 0
  v_mfma_f32_16x16x32_bf16 v[96:99], a[100:103], a[4:7], v[96:99]
  s_waitcnt lgkmcnt(10)
  buffer_load_dwordx4 v28, s[8:11], s21 offen offset:0 nt lds
  v_mfma_f32_16x16x32_bf16 v[96:99], a[104:107], a[8:11], v[96:99]
  s_waitcnt lgkmcnt(8)
  buffer_load_dwordx4 v29, s[8:11], s21 offen offset:1024 nt lds
  s_add_u32 s29, s29, 8192
  s_and_b32 s29, s29, 0xffff
  s_add_u32 s55, s55, 2048
  s_and_b32 s55, s55, 32767
  s_add_u32 s21, s80, s55
  s_add_u32 m0, s49, 65536
  v_mfma_f32_16x16x32_bf16 v[96:99], a[108:111], a[12:15], v[96:99]
  s_waitcnt lgkmcnt(7)
  buffer_load_dwordx4 v28, s[12:15], s22 offen offset:0 nt lds
  v_mfma_f32_16x16x32_bf16 v[104:107], a[108:111], a[28:31], 0
  s_waitcnt lgkmcnt(6)
  buffer_load_dwordx4 v29, s[12:15], s22 offen offset:1024 nt lds
  s_add_u32 s49, s49, 8192
  s_and_b32 s49, s49, 0xffff
  s_add_u32 s56, s56, 2048
  s_and_b32 s56, s56, 32767
  s_add_u32 s22, s81, s56
  s_add_u32 m0, s29, 0
  v_mfma_f32_16x16x32_bf16 v[104:107], a[104:107], a[24:27], v[104:107]
  s_waitcnt lgkmcnt(5)
  buffer_load_dwordx4 v28, s[8:11], s21 offen offset:0 nt lds
  v_mfma_f32_16x16x32_bf16 v[104:107], a[100:103], a[20:23], v[104:107]
  s_waitcnt lgkmcnt(4)
  buffer_load_dwordx4 v29, s[8:11], s21 offen offset:1024 nt lds
  s_add_u32 s29, s29, 8192
  s_and_b32 s29, s29, 0xffff
  s_add_u32 s55, s55, 2048
  s_and_b32 s55, s55, 32767
  s_add_u32 s21, s80, s55
  s_add_u32 m0, s49, 65536
  v_mfma_f32_16x16x32_bf16 v[104:107], a[96:99], a[16:19], v[104:107]
  s_waitcnt vmcnt(6) lgkmcnt(3)
  buffer_load_dwordx4 v28, s[12:15], s22 offen offset:0 nt lds
  v_mfma_f32_16x16x32_bf16 v[108:111], a[112:115], a[16:19], 0
  s_waitcnt lgkmcnt(2)
  buffer_load_dwordx4 v29, s[12:15], s22 offen offset:1024 nt lds
  s_add_u32 s49, s49, 8192
  s_and_b32 s49, s49, 0xffff
  s_add_u32 s56, s56, 2048
  s_and_b32 s56, s56, 32767
  s_add_u32 s22, s81, s56
  s_add_u32 m0, s29, 0
  v_mfma_f32_16x16x32_bf16 v[108:111], a[116:119], a[20:23], v[108:111]
  s_waitcnt lgkmcnt(1)
  buffer_load_dwordx4 v28, s[8:11], s21 offen offset:0 nt lds
  v_mfma_f32_16x16x32_bf16 v[108:111], a[120:123], a[24:27], v[108:111]
  s_waitcnt lgkmcnt(0)
  ds_read_b128 a[32:35], v12 offset:0
  ds_read_b128 a[36:39], v13 offset:0
  ds_read_b128 a[40:43], v14 offset:0
  ds_read_b128 a[44:47], v15 offset:0
  ds_read_b128 a[60:63], v15 offset:4096
  ds_read_b128 a[56:59], v14 offset:4096
  ds_read_b128 a[52:55], v13 offset:4096
  v_mfma_f32_16x16x32_bf16 v[108:111], a[124:127], a[28:31], v[108:111]
  buffer_load_dwordx4 v29, s[8:11], s21 offen offset:1024 nt lds
  s_add_u32 s29, s29, 8192
  s_and_b32 s29, s29, 0xffff
  s_add_u32 s55, s55, 2048
  s_and_b32 s55, s55, 32767
  s_add_u32 s21, s80, s55
  v_mfma_f32_16x16x32_bf16 v[100:103], a[124:127], a[12:15], 0
  ds_read_b128 a[48:51], v12 offset:4096
  v_mul_f32 v96, s27, v96
  v_mul_f32 v97, s27, v97
  v_mul_f32 v98, s27, v98
  v_mul_f32 v99, s27, v99
  v_exp_f32 v96, v96
  v_mfma_f32_16x16x32_bf16 v[100:103], a[120:123], a[8:11], v[100:103]
  v_exp_f32 v97, v97
  v_mfma_f32_16x16x32_bf16 v[100:103], a[116:119], a[4:7], v[100:103]
  v_cvt_pk_bf16_f32 v80, v96, v97
  v_mul_f32 v104, s27, v104
  v_exp_f32 v98, v98
  v_mfma_f32_16x16x32_bf16 v[100:103], a[112:115], a[0:3], v[100:103]
  s_waitcnt lgkmcnt(7)
  v_exp_f32 v99, v99
  v_mfma_f32_16x16x32_bf16 v[112:115], a[96:99], a[32:35], 0
  s_waitcnt lgkmcnt(6)
  v_cvt_pk_bf16_f32 v81, v98, v99
  v_mul_f32 v105, s27, v105
  v_mul_f32 v106, s27, v106
  v_mfma_f32_16x16x32_bf16 v[112:115], a[100:103], a[36:39], v[112:115]
  s_waitcnt lgkmcnt(5)
  v_exp_f32 v104, v104
  v_mul_f32 v107, s27, v107
  v_mfma_f32_16x16x32_bf16 v[112:115], a[104:107], a[40:43], v[112:115]
  s_waitcnt lgkmcnt(4)
  v_exp_f32 v105, v105
  v_mul_f32 v108, s27, v108
  v_mfma_f32_16x16x32_bf16 v[112:115], a[108:111], a[44:47], v[112:115]
  s_waitcnt lgkmcnt(3)
  v_cvt_pk_bf16_f32 v84, v104, v105
  v_mul_f32 v109, s27, v109
  v_mul_f32 v110, s27, v110
  v_mfma_f32_16x16x32_bf16 v[120:123], a[108:111], a[60:63], 0
  s_waitcnt lgkmcnt(2)
  v_exp_f32 v106, v106
  v_mul_f32 v100, s27, v100
  v_mfma_f32_16x16x32_bf16 v[120:123], a[104:107], a[56:59], v[120:123]
  s_waitcnt lgkmcnt(1)
  v_exp_f32 v107, v107
  v_mul_f32 v101, s27, v101
  v_mfma_f32_16x16x32_bf16 v[120:123], a[100:103], a[52:55], v[120:123]
  s_waitcnt lgkmcnt(0)
  v_cvt_pk_bf16_f32 v85, v106, v107
  v_mul_f32 v111, s27, v111
  v_mul_f32 v102, s27, v102
  v_mul_f32 v103, s27, v103
  v_mfma_f32_16x16x32_bf16 v[120:123], a[96:99], a[48:51], v[120:123]
  v_exp_f32 v108, v108
  v_exp_f32 v100, v100
  v_mfma_f32_16x16x32_bf16 v[124:127], a[112:115], a[48:51], 0
  s_waitcnt vmcnt(8)
  s_barrier
  v_mul_f32 v112, s27, v112
  v_mul_f32 v113, s27, v113
  v_exp_f32 v101, v101
  v_mfma_f32_16x16x32_bf16 v[124:127], a[116:119], a[52:55], v[124:127]
  ds_read_b64_tr_b16 a[128:129], v20 offset:0
  ds_read_b64_tr_b16 a[130:131], v20 offset:4096
  ds_read_b64_tr_b16 a[132:133], v21 offset:0
  v_mfma_f32_16x16x32_bf16 v[124:127], a[120:123], a[56:59], v[124:127]
  ds_read_b64_tr_b16 a[134:135], v21 offset:4096
  ds_read_b64_tr_b16 a[136:137], v22 offset:0
  ds_read_b64_tr_b16 a[138:139], v22 offset:4096
  v_mfma_f32_16x16x32_bf16 v[124:127], a[124:127], a[60:63], v[124:127]
  ds_read_b64_tr_b16 a[140:141], v23 offset:0
  ds_read_b64_tr_b16 a[142:143], v23 offset:4096
  v_exp_f32 v102, v102
  v_exp_f32 v103, v103
  v_mfma_f32_16x16x32_bf16 v[116:119], a[124:127], a[44:47], 0
  ds_read_b64_tr_b16 a[144:145], v24 offset:0
  ds_read_b64_tr_b16 a[146:147], v24 offset:4096
  v_exp_f32 v109, v109
  v_mfma_f32_16x16x32_bf16 v[116:119], a[120:123], a[40:43], v[116:119]
  ds_read_b64_tr_b16 a[148:149], v25 offset:0
  ds_read_b64_tr_b16 a[150:151], v25 offset:4096
  v_exp_f32 v110, v110
  v_exp_f32 v111, v111
  v_mfma_f32_16x16x32_bf16 v[116:119], a[116:119], a[36:39], v[116:119]
  v_cvt_pk_bf16_f32 v82, v100, v101
  v_cvt_pk_bf16_f32 v83, v102, v103
  v_mfma_f32_16x16x32_bf16 v[116:119], a[112:115], a[32:35], v[116:119]
  s_waitcnt lgkmcnt(10)
  v_cvt_pk_bf16_f32 v86, v108, v109
  v_cvt_pk_bf16_f32 v87, v110, v111
  v_mfma_f32_16x16x32_bf16 v[128:131], a[128:131], v[80:83], 0
  ds_read_b64_tr_b16 a[152:153], v26 offset:0
  ds_read_b64_tr_b16 a[154:155], v26 offset:4096
  v_mfma_f32_16x16x32_bf16 v[160:163], a[128:131], v[84:87], 0
  s_waitcnt lgkmcnt(10)
  v_exp_f32 v112, v112
  v_mfma_f32_16x16x32_bf16 v[132:135], a[132:135], v[80:83], 0
  ds_read_b64_tr_b16 a[156:157], v27 offset:0
  ds_read_b64_tr_b16 a[158:159], v27 offset:4096
  v_mfma_f32_16x16x32_bf16 v[164:167], a[132:135], v[84:87], 0
  s_waitcnt lgkmcnt(10)
  v_exp_f32 v113, v113
  v_mfma_f32_16x16x32_bf16 v[136:139], a[136:139], v[80:83], 0
  v_mul_f32 v114, s27, v114
  v_cvt_pk_bf16_f32 v88, v112, v113
  v_mfma_f32_16x16x32_bf16 v[168:171], a[136:139], v[84:87], 0
  v_exp_f32 v114, v114
  v_mfma_f32_16x16x32_bf16 a[224:227], a[240:243], v[80:83], 0
  s_waitcnt lgkmcnt(8)
  ds_read_b128 a[96:99], v16 offset:8192
  v_mul_f32 v115, s27, v115
  v_mfma_f32_16x16x32_bf16 v[140:143], a[140:143], v[80:83], 0
  v_exp_f32 v115, v115
  v_mfma_f32_16x16x32_bf16 v[172:175], a[140:143], v[84:87], 0
  s_waitcnt lgkmcnt(7)
  ds_read_b128 a[100:103], v17 offset:8192
  v_mul_f32 v120, s27, v120
  v_cvt_pk_bf16_f32 v89, v114, v115
  v_mfma_f32_16x16x32_bf16 v[144:147], a[144:147], v[80:83], 0
  v_exp_f32 v120, v120
  v_mfma_f32_16x16x32_bf16 v[176:179], a[144:147], v[84:87], 0
  s_waitcnt lgkmcnt(6)
  ds_read_b128 a[104:107], v18 offset:8192
  v_mul_f32 v121, s27, v121
  v_mfma_f32_16x16x32_bf16 v[148:151], a[148:151], v[80:83], 0
  v_exp_f32 v121, v121
  v_mfma_f32_16x16x32_bf16 v[180:183], a[148:151], v[84:87], 0
  v_mul_f32 v122, s27, v122
  v_cvt_pk_bf16_f32 v92, v120, v121
  v_mfma_f32_16x16x32_bf16 a[228:231], a[240:243], v[84:87], 0
  s_waitcnt lgkmcnt(5)
  ds_read_b128 a[108:111], v19 offset:8192
  v_exp_f32 v122, v122
  v_mfma_f32_16x16x32_bf16 v[152:155], a[152:155], v[80:83], 0
  ds_read_b128 a[112:115], v16 offset:12288
  v_mul_f32 v123, s27, v123
  v_exp_f32 v123, v123
  v_mfma_f32_16x16x32_bf16 v[184:187], a[152:155], v[84:87], 0
  s_waitcnt lgkmcnt(5)
  v_mul_f32 v124, s27, v124
  v_cvt_pk_bf16_f32 v93, v122, v123
  v_mfma_f32_16x16x32_bf16 v[156:159], a[156:159], v[80:83], 0
  v_exp_f32 v124, v124
  v_mul_f32 v125, s27, v125
  v_mfma_f32_16x16x32_bf16 v[188:191], a[156:159], v[84:87], 0
  s_waitcnt lgkmcnt(4)
  ds_read_b128 a[116:119], v17 offset:12288
  s_waitcnt vmcnt(4)
  s_barrier
  v_exp_f32 v125, v125
  s_branch L_it1
L_ramp2A:
  s_bitcmp1_b32 s2, 3
  s_cbranch_scc1 L_ramp2B
  s_waitcnt vmcnt(2)
  s_add_u32 m0, s49, 65536
  s_nop 0
  buffer_load_dwordx4 v28, s[12:15], s22 offen offset:0 nt lds
  buffer_load_dwordx4 v29, s[12:15], s22 offen offset:1024 nt lds
  s_add_u32 s49, s49, 8192
  s_and_b32 s49, s49, 0xffff
  s_add_u32 s56, s56, 2048
  s_and_b32 s56, s56, 32767
  s_add_u32 s22, s81, s56
  s_add_u32 m0, s29, 0
  s_nop 0
  buffer_load_dwordx4 v28, s[8:11], s21 offen offset:0 nt lds
  buffer_load_dwordx4 v29, s[8:11], s21 offen offset:1024 nt lds
  s_add_u32 s29, s29, 8192
  s_and_b32 s29, s29, 0xffff
  s_add_u32 s55, s55, 2048
  s_and_b32 s55, s55, 32767
  s_add_u32 s21, s80, s55
  s_branch L_back2
L_ramp2B:
  s_waitcnt vmcnt(2)
  s_add_u32 m0, s49, 65536
  s_nop 0
  buffer_load_dwordx4 v28, s[12:15], s22 offen offset:0 nt lds
  buffer_load_dwordx4 v29, s[12:15], s22 offen offset:1024 nt lds
  s_add_u32 s49, s49, 8192
  s_and_b32 s49, s49, 0xffff
  s_add_u32 s56, s56, 2048
  s_and_b32 s56, s56, 32767
  s_add_u32 s22, s81, s56
  s_add_u32 m0, s29, 0
  s_nop 0
  buffer_load_dwordx4 v28, s[8:11], s21 offen offset:0 nt lds
  buffer_load_dwordx4 v29, s[8:11], s21 offen offset:1024 nt lds
  s_add_u32 s29, s29, 8192
  s_and_b32 s29, s29, 0xffff
  s_add_u32 s55, s55, 2048
  s_and_b32 s55, s55, 32767
  s_add_u32 s21, s80, s55
  s_branch L_back2
L_ramp4A:
  s_bitcmp1_b32 s2, 3
  s_cbranch_scc1 L_ramp4B
  s_waitcnt vmcnt(8)
  s_add_u32 m0, s49, 65536
  s_nop 0
  buffer_load_dwordx4 v28, s[12:15], s22 offen offset:0 nt lds
  buffer_load_dwordx4 v29, s[12:15], s22 offen offset:1024 nt lds
  s_add_u32 s49, s49, 8192
  s_and_b32 s49, s49, 0xffff
  s_add_u32 s56, s56, 2048
  s_and_b32 s56, s56, 32767
  s_add_u32 s22, s81, s56
  s_add_u32 m0, s29, 0
  s_nop 0
  buffer_load_dwordx4 v28, s[8:11], s21 offen offset:0 nt lds
  buffer_load_dwordx4 v29, s[8:11], s21 offen offset:1024 nt lds
  s_add_u32 s29, s29, 8192
  s_and_b32 s29, s29, 0xffff
  s_add_u32 s55, s55, 2048
  s_and_b32 s55, s55, 32767
  s_add_u32 s21, s80, s55
  s_mov_b64 vcc, 0
  s_branch L_back4
L_ramp4B:
  s_waitcnt vmcnt(8)
  s_add_u32 m0, s49, 65536
  s_nop 0
  buffer_load_dwordx4 v28, s[12:15], s22 offen offset:0 nt lds
  buffer_load_dwordx4 v29, s[12:15], s22 offen offset:1024 nt lds
  s_add_u32 s49, s49, 8192
  s_and_b32 s49, s49, 0xffff
  s_add_u32 s56, s56, 2048
  s_and_b32 s56, s56, 32767
  s_add_u32 s22, s81, s56
  s_add_u32 m0, s29, 0
  s_nop 0
  buffer_load_dwordx4 v28, s[8:11], s21 offen offset:0 nt lds
  buffer_load_dwordx4 v29, s[8:11], s21 offen offset:1024 nt lds
  s_add_u32 s29, s29, 8192
  s_and_b32 s29, s29, 0xffff
  s_add_u32 s55, s55, 2048
  s_and_b32 s55, s55, 32767
  s_add_u32 s21, s80, s55
  s_mov_b64 vcc, 0
  s_branch L_back4
.p2align 6
L_it0:
  v_accvgpr_read_b32 v42, a224
  v_accvgpr_read_b32 v43, a228
  v_rcp_f32 v44, v42
  v_rcp_f32 v46, v43
  v_subrev_u32 v36, s34, v42
  v_subrev_u32 v37, s34, v43
  v_cmp_le_u32 vcc, s35, v36
  v_cmp_le_u32 s[32:33], s35, v37
  v_pk_mul_f32 v[128:129], v[128:129], v[44:45] op_sel_hi:[1,0]
  v_pk_mul_f32 v[130:131], v[130:131], v[44:45] op_sel_hi:[1,0]
  v_pk_mul_f32 v[132:133], v[132:133], v[44:45] op_sel_hi:[1,0]
  v_pk_mul_f32 v[134:135], v[134:135], v[44:45] op_sel_hi:[1,0]
  v_pk_mul_f32 v[136:137], v[136:137], v[44:45] op_sel_hi:[1,0]
  v_pk_mul_f32 v[138:139], v[138:139], v[44:45] op_sel_hi:[1,0]
  v_pk_mul_f32 v[140:141], v[140:141], v[44:45] op_sel_hi:[1,0]
  v_pk_mul_f32 v[142:143], v[142:143], v[44:45] op_sel_hi:[1,0]
  v_pk_mul_f32 v[144:145], v[144:145], v[44:45] op_sel_hi:[1,0]
  v_pk_mul_f32 v[146:147], v[146:147], v[44:45] op_sel_hi:[1,0]
  v_pk_mul_f32 v[148:149], v[148:149], v[44:45] op_sel_hi:[1,0]
  v_pk_mul_f32 v[150:151], v[150:151], v[44:45] op_sel_hi:[1,0]
  v_pk_mul_f32 v[152:153], v[152:153], v[44:45] op_sel_hi:[1,0]
  v_pk_mul_f32 v[154:155], v[154:155], v[44:45] op_sel_hi:[1,0]
  v_pk_mul_f32 v[156:157], v[156:157], v[44:45] op_sel_hi:[1,0]
  v_pk_mul_f32 v[158:159], v[158:159], v[44:45] op_sel_hi:[1,0]
  v_pk_mul_f32 v[160:161], v[160:161], v[46:47] op_sel_hi:[1,0]
  v_pk_mul_f32 v[162:163], v[162:163], v[46:47] op_sel_hi:[1,0]
  v_pk_mul_f32 v[164:165], v[164:165], v[46:47] op_sel_hi:[1,0]
  v_pk_mul_f32 v[166:167], v[166:167], v[46:47] op_sel_hi:[1,0]
  v_pk_mul_f32 v[168:169], v[168:169], v[46:47] op_sel_hi:[1,0]
  v_pk_mul_f32 v[170:171], v[170:171], v[46:47] op_sel_hi:[1,0]
  v_pk_mul_f32 v[172:173], v[172:173], v[46:47] op_sel_hi:[1,0]
  v_pk_mul_f32 v[174:175], v[174:175], v[46:47] op_sel_hi:[1,0]
  v_pk_mul_f32 v[176:177], v[176:177], v[46:47] op_sel_hi:[1,0]
  v_pk_mul_f32 v[178:179], v[178:179], v[46:47] op_sel_hi:[1,0]
  v_pk_mul_f32 v[180:181], v[180:181], v[46:47] op_sel_hi:[1,0]
  v_pk_mul_f32 v[182:183], v[182:183], v[46:47] op_sel_hi:[1,0]
  v_pk_mul_f32 v[184:185], v[184:185], v[46:47] op_sel_hi:[1,0]
  v_pk_mul_f32 v[186:187], v[186:187], v[46:47] op_sel_hi:[1,0]
  v_pk_mul_f32 v[188:189], v[188:189], v[46:47] op_sel_hi:[1,0]
  v_pk_mul_f32 v[190:191], v[190:191], v[46:47] op_sel_hi:[1,0]
  v_cvt_pk_bf16_f32 v128, v128, v129
  v_cvt_pk_bf16_f32 v129, v130, v131
  v_cvt_pk_bf16_f32 v130, v132, v133
  v_cvt_pk_bf16_f32 v131, v134, v135
  v_cvt_pk_bf16_f32 v136, v136, v137
  v_cvt_pk_bf16_f32 v137, v138, v139
  v_cvt_pk_bf16_f32 v138, v140, v141
  v_cvt_pk_bf16_f32 v139, v142, v143
  v_mfma_f32_16x16x32_bf16 a[248:251], a[244:247], v[128:131], 0
  s_or_b64 s[30:31], s[30:31], vcc
  v_cvt_pk_bf16_f32 v144, v144, v145
  v_cvt_pk_bf16_f32 v145, v146, v147
  v_cvt_pk_bf16_f32 v146, v148, v149
  v_cvt_pk_bf16_f32 v147, v150, v151
  v_mfma_f32_16x16x32_bf16 a[248:251], a[244:247], v[136:139], a[248:251]
  s_or_b64 s[30:31], s[30:31], s[32:33]
  v_cvt_pk_bf16_f32 v152, v152, v153
  v_cvt_pk_bf16_f32 v153, v154, v155
  v_cvt_pk_bf16_f32 v154, v156, v157
  v_cvt_pk_bf16_f32 v155, v158, v159
  v_mfma_f32_16x16x32_bf16 a[248:251], a[244:247], v[144:147], a[248:251]
  v_cvt_pk_bf16_f32 v160, v160, v161
  v_cvt_pk_bf16_f32 v161, v162, v163
  v_cvt_pk_bf16_f32 v162, v164, v165
  v_cvt_pk_bf16_f32 v163, v166, v167
  v_mfma_f32_16x16x32_bf16 a[248:251], a[244:247], v[152:155], a[248:251]
  v_cvt_pk_bf16_f32 v168, v168, v169
  v_cvt_pk_bf16_f32 v169, v170, v171
  v_cvt_pk_bf16_f32 v170, v172, v173
  v_cvt_pk_bf16_f32 v171, v174, v175
  v_mfma_f32_16x16x32_bf16 a[248:251], a[244:247], v[160:163], a[248:251]
  v_cvt_pk_bf16_f32 v176, v176, v177
  v_cvt_pk_bf16_f32 v177, v178, v179
  v_cvt_pk_bf16_f32 v178, v180, v181
  v_cvt_pk_bf16_f32 v179, v182, v183
  v_mfma_f32_16x16x32_bf16 a[248:251], a[244:247], v[168:171], a[248:251]
  v_cvt_pk_bf16_f32 v184, v184, v185
  v_cvt_pk_bf16_f32 v185, v186, v187
  v_cvt_pk_bf16_f32 v186, v188, v189
  v_cvt_pk_bf16_f32 v187, v190, v191
  v_mfma_f32_16x16x32_bf16 a[248:251], a[244:247], v[176:179], a[248:251]
  v_mfma_f32_16x16x32_bf16 v[96:99], a[96:99], a[0:3], 0
  s_waitcnt lgkmcnt(4)
  ds_read_b128 a[120:123], v18 offset:4096
  ds_read_b128 a[124:127], v19 offset:4096
  v_mul_f32 v126, s27, v126
  v_cvt_pk_bf16_f32 v94, v124, v125
  v_mul_f32 v116, s27, v116
  v_mul_f32 v117, s27, v117
  v_mul_f32 v118, s27, v118
  v_mfma_f32_16x16x32_bf16 a[248:251], a[244:247], v[184:187], a[248:251]
  v_mfma_f32_16x16x32_bf16 v[96:99], a[100:103], a[4:7], v[96:99]
  s_waitcnt lgkmcnt(5)
  v_accvgpr_mov_b32 a48, a80
  v_mul_f32 v127, s27, v127
  v_mul_f32 v119, s27, v119
  v_mfma_f32_16x16x32_bf16 v[96:99], a[104:107], a[8:11], v[96:99]
  s_waitcnt lgkmcnt(4)
  v_exp_f32 v126, v126
  v_exp_f32 v116, v116
  v_mfma_f32_16x16x32_bf16 v[96:99], a[108:111], a[12:15], v[96:99]
  ds_write_b128 v34, v[128:131] offset:0
  v_mfma_f32_16x16x32_bf16 v[104:107], a[108:111], a[28:31], 0
  v_accvgpr_mov_b32 a49, a81
  v_accvgpr_mov_b32 a50, a82
  v_exp_f32 v117, v117
  v_mfma_f32_16x16x32_bf16 v[104:107], a[104:107], a[24:27], v[104:107]
  v_exp_f32 v127, v127
  v_mfma_f32_16x16x32_bf16 v[104:107], a[100:103], a[20:23], v[104:107]
  v_cvt_pk_bf16_f32 v95, v126, v127
  v_accvgpr_mov_b32 a51, a83
  v_exp_f32 v118, v118
  v_mfma_f32_16x16x32_bf16 v[104:107], a[96:99], a[16:19], v[104:107]
  s_waitcnt lgkmcnt(4)
  ds_write_b128 v35, v[136:139] offset:0
  v_mfma_f32_16x16x32_bf16 v[108:111], a[112:115], a[16:19], 0
  s_waitcnt lgkmcnt(4)
  v_cvt_pk_bf16_f32 v90, v116, v117
  v_accvgpr_mov_b32 a52, a84
  v_exp_f32 v119, v119
  v_mfma_f32_16x16x32_bf16 v[108:111], a[116:119], a[20:23], v[108:111]
  s_waitcnt lgkmcnt(3)
  ds_write_b128 v34, v[144:147] offset:128
  v_mfma_f32_16x16x32_bf16 v[108:111], a[120:123], a[24:27], v[108:111]
  s_waitcnt lgkmcnt(3)
  v_accvgpr_mov_b32 a53, a85
  v_cvt_pk_bf16_f32 v91, v118, v119
  v_accvgpr_mov_b32 a54, a86
  v_mfma_f32_16x16x32_bf16 v[108:111], a[124:127], a[28:31], v[108:111]
  ds_write_b128 v35, v[152:155] offset:128
  v_accvgpr_mov_b32 a55, a87
  v_mfma_f32_16x16x32_bf16 v[100:103], a[124:127], a[12:15], 0
  v_mul_f32 v96, s27, v96
  v_accvgpr_mov_b32 a56, a88
  v_accvgpr_mov_b32 a57, a89
  v_mfma_f32_16x16x32_bf16 v[100:103], a[120:123], a[8:11], v[100:103]
  s_waitcnt vmcnt(14)
  v_exp_f32 v96, v96
  v_accvgpr_mov_b32 a58, a90
  v_mfma_f32_16x16x32_bf16 v[100:103], a[116:119], a[4:7], v[100:103]
  s_barrier
  ds_write_b128 v34, v[160:163] offset:4096
  v_accvgpr_mov_b32 a59, a91
  v_mfma_f32_16x16x32_bf16 v[100:103], a[112:115], a[0:3], v[100:103]
  v_mul_f32 v97, s27, v97
  v_mul_f32 v98, s27, v98
  v_accvgpr_mov_b32 a60, a92
  v_mfma_f32_16x16x32_bf16 v[192:195], a[128:131], v[88:91], v[192:195]
  s_add_u32 m0, s29, 0
  v_exp_f32 v97, v97
  v_accvgpr_mov_b32 a61, a93
  v_mfma_f32_16x16x32_bf16 v[224:227], a[128:131], v[92:95], v[224:227]
  buffer_load_dwordx4 v28, s[8:11], s21 offen offset:0 nt lds
  v_mfma_f32_16x16x32_bf16 v[196:199], a[132:135], v[88:91], v[196:199]
  ds_read_b64_tr_b16 a[128:129], v20 offset:0
  v_cvt_pk_bf16_f32 v80, v96, v97
  v_accvgpr_mov_b32 a62, a94
  v_mfma_f32_16x16x32_bf16 v[228:231], a[132:135], v[92:95], v[228:231]
  ds_write_b128 v35, v[168:171] offset:4096
  v_accvgpr_mov_b32 a63, a95
  v_mfma_f32_16x16x32_bf16 v[200:203], a[136:139], v[88:91], v[200:203]
  ds_write_b128 v34, v[176:179] offset:4224
  v_exp_f32 v98, v98
  v_mfma_f32_16x16x32_bf16 v[232:235], a[136:139], v[92:95], v[232:235]
  ds_read_b64_tr_b16 a[130:131], v20 offset:4096
  v_mul_f32 v99, s27, v99
  v_mfma_f32_16x16x32_bf16 a[232:235], a[240:243], v[88:91], a[232:235]
  ds_write_b128 v35, v[184:187] offset:4224
  v_exp_f32 v99, v99
  v_mfma_f32_16x16x32_bf16 v[204:207], a[140:143], v[88:91], v[204:207]
  v_mul_f32 v104, s27, v104
  v_cvt_pk_bf16_f32 v81, v98, v99
  v_mfma_f32_16x16x32_bf16 v[236:239], a[140:143], v[92:95], v[236:239]
  ds_read_b64_tr_b16 a[132:133], v21 offset:0
  ds_read_b64_tr_b16 a[134:135], v21 offset:4096
  v_mul_f32 v105, s27, v105
  v_mfma_f32_16x16x32_bf16 v[208:211], a[144:147], v[88:91], v[208:211]
  buffer_load_dwordx4 v29, s[8:11], s21 offen offset:1024 nt lds
  v_mfma_f32_16x16x32_bf16 v[240:243], a[144:147], v[92:95], v[240:243]
  s_add_u32 s29, s29, 8192
  v_exp_f32 v104, v104
  v_mul_f32 v100, s27, v100
  v_mfma_f32_16x16x32_bf16 v[212:215], a[148:151], v[88:91], v[212:215]
  s_and_b32 s29, s29, 0xffff
  v_exp_f32 v105, v105
  v_mul_f32 v101, s27, v101
  v_mfma_f32_16x16x32_bf16 v[244:247], a[148:151], v[92:95], v[244:247]
  s_add_u32 s55, s55, 2048
  v_mul_f32 v106, s27, v106
  v_cvt_pk_bf16_f32 v84, v104, v105
  v_mul_f32 v102, s27, v102
  v_mfma_f32_16x16x32_bf16 a[236:239], a[240:243], v[92:95], a[236:239]
  s_and_b32 s55, s55, 32767
  v_exp_f32 v106, v106
  v_mul_f32 v103, s27, v103
  v_mfma_f32_16x16x32_bf16 v[216:219], a[152:155], v[88:91], v[216:219]
  s_add_u32 s21, s80, s55
  ds_read_b64_tr_b16 a[136:137], v22 offset:0
  ds_read_b64 a[160:161], v8 offset:0
  v_mul_f32 v107, s27, v107
  v_mfma_f32_16x16x32_bf16 v[248:251], a[152:155], v[92:95], v[248:251]
  v_exp_f32 v107, v107
  v_mul_f32 v108, s27, v108
  v_mfma_f32_16x16x32_bf16 v[220:223], a[156:159], v[88:91], v[220:223]
  s_add_u32 m0, s49, 65536
  ds_read_b64 a[162:163], v9 offset:0
  ds_read_b64_tr_b16 a[138:139], v22 offset:4096
  v_cvt_pk_bf16_f32 v85, v106, v107
  v_mfma_f32_16x16x32_bf16 v[252:255], a[156:159], v[92:95], v[252:255]
  buffer_load_dwordx4 v28, s[12:15], s22 offen offset:0 nt lds
  v_mfma_f32_16x16x32_bf16 v[112:115], a[96:99], a[32:35], 0
  ds_read_b64 a[164:165], v10 offset:1024
  v_exp_f32 v108, v108
  v_mfma_f32_16x16x32_bf16 v[112:115], a[100:103], a[36:39], v[112:115]
  ds_read_b64 a[166:167], v11 offset:1024
  ds_read_b64_tr_b16 a[140:141], v23 offset:0
  v_mul_f32 v109, s27, v109
  v_mfma_f32_16x16x32_bf16 v[112:115], a[104:107], a[40:43], v[112:115]
  ds_read_b64 a[168:169], v8 offset:2048
  v_exp_f32 v109, v109
  v_mfma_f32_16x16x32_bf16 v[112:115], a[108:111], a[44:47], v[112:115]
  ds_read_b64 a[170:171], v9 offset:2048
  v_mul_f32 v110, s27, v110
  v_cvt_pk_bf16_f32 v86, v108, v109
  v_mfma_f32_16x16x32_bf16 v[120:123], a[108:111], a[60:63], 0
  ds_read_b64_tr_b16 a[142:143], v23 offset:4096
  v_exp_f32 v110, v110
  v_mfma_f32_16x16x32_bf16 v[120:123], a[104:107], a[56:59], v[120:123]
  ds_read_b64 a[172:173], v10 offset:3072
  ds_read_b64 a[174:175], v11 offset:3072
  v_mul_f32 v111, s27, v111
  v_mfma_f32_16x16x32_bf16 v[120:123], a[100:103], a[52:55], v[120:123]
  ds_read_b64 a[176:177], v8 offset:4096
  v_exp_f32 v111, v111
  v_mfma_f32_16x16x32_bf16 v[120:123], a[96:99], a[48:51], v[120:123]
  buffer_load_dwordx4 v29, s[12:15], s22 offen offset:1024 nt lds
  v_mfma_f32_16x16x32_bf16 v[124:127], a[112:115], a[48:51], 0
  s_add_u32 s49, s49, 8192
  ds_read_b64_tr_b16 a[144:145], v24 offset:0
  ds_read_b64 a[178:179], v9 offset:4096
  v_cvt_pk_bf16_f32 v87, v110, v111
  v_mfma_f32_16x16x32_bf16 v[124:127], a[116:119], a[52:55], v[124:127]
  s_and_b32 s49, s49, 0xffff
  ds_read_b64 a[180:181], v10 offset:5120
  v_exp_f32 v100, v100
  v_mfma_f32_16x16x32_bf16 v[124:127], a[120:123], a[56:59], v[124:127]
  s_add_u32 s56, s56, 2048
  ds_read_b64_tr_b16 a[146:147], v24 offset:4096
  ds_read_b64 a[182:183], v11 offset:5120
  ds_read_b64 a[184:185], v8 offset:6144
  v_mfma_f32_16x16x32_bf16 v[124:127], a[124:127], a[60:63], v[124:127]
  s_and_b32 s56, s56, 32767
  ds_read_b64_tr_b16 a[148:149], v25 offset:0
  v_exp_f32 v101, v101
  v_exp_f32 v102, v102
  v_mfma_f32_16x16x32_bf16 v[116:119], a[124:127], a[44:47], 0
  s_add_u32 s22, s81, s56
  ds_read_b64 a[186:187], v9 offset:6144
  ds_read_b64 a[188:189], v10 offset:7168
  v_cvt_pk_bf16_f32 v82, v100, v101
  v_mfma_f32_16x16x32_bf16 v[116:119], a[120:123], a[40:43], v[116:119]
  ds_read_b64 a[190:191], v11 offset:7168
  ds_read_b64_tr_b16 a[150:151], v25 offset:4096
  v_exp_f32 v103, v103
  v_accvgpr_read_b32 v42, a232
  v_accvgpr_read_b32 v43, a236
  v_rcp_f32 v44, v42
  v_rcp_f32 v46, v43
  v_subrev_u32 v36, s34, v42
  v_subrev_u32 v37, s34, v43
  v_cmp_le_u32 vcc, s35, v36
  v_cmp_le_u32 s[32:33], s35, v37
  v_pk_mul_f32 v[192:193], v[192:193], v[44:45] op_sel_hi:[1,0]
  v_pk_mul_f32 v[194:195], v[194:195], v[44:45] op_sel_hi:[1,0]
  v_pk_mul_f32 v[196:197], v[196:197], v[44:45] op_sel_hi:[1,0]
  v_pk_mul_f32 v[198:199], v[198:199], v[44:45] op_sel_hi:[1,0]
  v_pk_mul_f32 v[200:201], v[200:201], v[44:45] op_sel_hi:[1,0]
  v_pk_mul_f32 v[202:203], v[202:203], v[44:45] op_sel_hi:[1,0]
  v_pk_mul_f32 v[204:205], v[204:205], v[44:45] op_sel_hi:[1,0]
  v_pk_mul_f32 v[206:207], v[206:207], v[44:45] op_sel_hi:[1,0]
  v_pk_mul_f32 v[208:209], v[208:209], v[44:45] op_sel_hi:[1,0]
  v_pk_mul_f32 v[210:211], v[210:211], v[44:45] op_sel_hi:[1,0]
  v_pk_mul_f32 v[212:213], v[212:213], v[44:45] op_sel_hi:[1,0]
  v_pk_mul_f32 v[214:215], v[214:215], v[44:45] op_sel_hi:[1,0]
  v_pk_mul_f32 v[216:217], v[216:217], v[44:45] op_sel_hi:[1,0]
  v_pk_mul_f32 v[218:219], v[218:219], v[44:45] op_sel_hi:[1,0]
  v_pk_mul_f32 v[220:221], v[220:221], v[44:45] op_sel_hi:[1,0]
  v_pk_mul_f32 v[222:223], v[222:223], v[44:45] op_sel_hi:[1,0]
  v_pk_mul_f32 v[224:225], v[224:225], v[46:47] op_sel_hi:[1,0]
  v_pk_mul_f32 v[226:227], v[226:227], v[46:47] op_sel_hi:[1,0]
  v_pk_mul_f32 v[228:229], v[228:229], v[46:47] op_sel_hi:[1,0]
  v_pk_mul_f32 v[230:231], v[230:231], v[46:47] op_sel_hi:[1,0]
  v_pk_mul_f32 v[232:233], v[232:233], v[46:47] op_sel_hi:[1,0]
  v_pk_mul_f32 v[234:235], v[234:235], v[46:47] op_sel_hi:[1,0]
  v_pk_mul_f32 v[236:237], v[236:237], v[46:47] op_sel_hi:[1,0]
  v_pk_mul_f32 v[238:239], v[238:239], v[46:47] op_sel_hi:[1,0]
  v_pk_mul_f32 v[240:241], v[240:241], v[46:47] op_sel_hi:[1,0]
  v_pk_mul_f32 v[242:243], v[242:243], v[46:47] op_sel_hi:[1,0]
  v_pk_mul_f32 v[244:245], v[244:245], v[46:47] op_sel_hi:[1,0]
  v_pk_mul_f32 v[246:247], v[246:247], v[46:47] op_sel_hi:[1,0]
  v_pk_mul_f32 v[248:249], v[248:249], v[46:47] op_sel_hi:[1,0]
  v_pk_mul_f32 v[250:251], v[250:251], v[46:47] op_sel_hi:[1,0]
  v_pk_mul_f32 v[252:253], v[252:253], v[46:47] op_sel_hi:[1,0]
  v_pk_mul_f32 v[254:255], v[254:255], v[46:47] op_sel_hi:[1,0]
  v_cvt_pk_bf16_f32 v192, v192, v193
  v_cvt_pk_bf16_f32 v193, v194, v195
  v_cvt_pk_bf16_f32 v194, v196, v197
  v_cvt_pk_bf16_f32 v195, v198, v199
  v_cvt_pk_bf16_f32 v200, v200, v201
  v_cvt_pk_bf16_f32 v201, v202, v203
  v_cvt_pk_bf16_f32 v202, v204, v205
  v_cvt_pk_bf16_f32 v203, v206, v207
  v_mfma_f32_16x16x32_bf16 a[248:251], a[244:247], v[192:195], a[248:251]
  s_or_b64 s[30:31], s[30:31], vcc
  v_cvt_pk_bf16_f32 v208, v208, v209
  v_cvt_pk_bf16_f32 v209, v210, v211
  v_cvt_pk_bf16_f32 v210, v212, v213
  v_cvt_pk_bf16_f32 v211, v214, v215
  v_mfma_f32_16x16x32_bf16 a[248:251], a[244:247], v[200:203], a[248:251]
  s_or_b64 s[30:31], s[30:31], s[32:33]
  v_cvt_pk_bf16_f32 v216, v216, v217
  v_cvt_pk_bf16_f32 v217, v218, v219
  v_cvt_pk_bf16_f32 v218, v220, v221
  v_cvt_pk_bf16_f32 v219, v222, v223
  v_mfma_f32_16x16x32_bf16 a[248:251], a[244:247], v[208:211], a[248:251]
  v_cvt_pk_bf16_f32 v224, v224, v225
  v_cvt_pk_bf16_f32 v225, v226, v227
  v_cvt_pk_bf16_f32 v226, v228, v229
  v_cvt_pk_bf16_f32 v227, v230, v231
  v_mfma_f32_16x16x32_bf16 a[248:251], a[244:247], v[216:219], a[248:251]
  v_cvt_pk_bf16_f32 v232, v232, v233
  v_cvt_pk_bf16_f32 v233, v234, v235
  v_cvt_pk_bf16_f32 v234, v236, v237
  v_cvt_pk_bf16_f32 v235, v238, v239
  v_mfma_f32_16x16x32_bf16 a[248:251], a[244:247], v[224:227], a[248:251]
  v_cvt_pk_bf16_f32 v240, v240, v241
  v_cvt_pk_bf16_f32 v241, v242, v243
  v_cvt_pk_bf16_f32 v242, v244, v245
  v_cvt_pk_bf16_f32 v243, v246, v247
  v_mfma_f32_16x16x32_bf16 a[248:251], a[244:247], v[232:235], a[248:251]
  v_cvt_pk_bf16_f32 v248, v248, v249
  v_cvt_pk_bf16_f32 v249, v250, v251
  v_cvt_pk_bf16_f32 v250, v252, v253
  v_cvt_pk_bf16_f32 v251, v254, v255
  v_mfma_f32_16x16x32_bf16 a[248:251], a[244:247], v[240:243], a[248:251]
  v_mfma_f32_16x16x32_bf16 v[116:119], a[116:119], a[36:39], v[116:119]
  ds_read_b64_tr_b16 a[152:153], v26 offset:0
  v_cvt_pk_bf16_f32 v83, v102, v103
  v_mfma_f32_16x16x32_bf16 a[248:251], a[244:247], v[248:251], a[248:251]
  v_mfma_f32_16x16x32_bf16 v[116:119], a[112:115], a[32:35], v[116:119]
  s_waitcnt lgkmcnt(15)
  v_mul_f32 v112, s27, v112
  v_mul_f32 v113, s27, v113
  v_mfma_f32_16x16x32_bf16 v[128:131], a[128:131], v[80:83], 0
  v_exp_f32 v112, v112
  v_mfma_f32_16x16x32_bf16 v[160:163], a[128:131], v[84:87], 0
  ds_write_b128 v34, v[192:195] offset:0
  ds_read_b64_tr_b16 a[154:155], v26 offset:4096
  v_mfma_f32_16x16x32_bf16 v[132:135], a[132:135], v[80:83], 0
  ds_read_b64_tr_b16 a[156:157], v27 offset:0
  v_exp_f32 v113, v113
  v_mfma_f32_16x16x32_bf16 v[164:167], a[132:135], v[84:87], 0
  ds_read_b64_tr_b16 a[158:159], v27 offset:4096
  v_mul_f32 v114, s27, v114
  v_cvt_pk_bf16_f32 v88, v112, v113
  v_mfma_f32_16x16x32_bf16 v[136:139], a[136:139], v[80:83], 0
  ds_read_b128 a[96:99], v16 offset:8192
  v_exp_f32 v114, v114
  v_mfma_f32_16x16x32_bf16 v[168:171], a[136:139], v[84:87], 0
  ds_write_b128 v35, v[200:203] offset:0
  ds_read_b128 a[100:103], v17 offset:8192
  v_mfma_f32_16x16x32_bf16 a[224:227], a[240:243], v[80:83], 0
  ds_read_b128 a[104:107], v18 offset:8192
  v_mul_f32 v115, s27, v115
  v_mul_f32 v120, s27, v120
  v_mfma_f32_16x16x32_bf16 v[140:143], a[140:143], v[80:83], 0
  ds_read_b128 a[108:111], v19 offset:8192
  v_exp_f32 v115, v115
  v_mfma_f32_16x16x32_bf16 v[172:175], a[140:143], v[84:87], 0
  s_waitcnt lgkmcnt(15)
  v_cvt_pk_bf16_f32 v89, v114, v115
  v_accvgpr_read_b32 v42, a248
  v_cmp_u_f32 vcc, v42, v42
  v_mfma_f32_16x16x32_bf16 v[144:147], a[144:147], v[80:83], 0
  ds_write_b128 v34, v[208:211] offset:128
  v_exp_f32 v120, v120
  v_mfma_f32_16x16x32_bf16 v[176:179], a[144:147], v[84:87], 0
  s_waitcnt lgkmcnt(11)
  v_mul_f32 v121, s27, v121
  v_mul_f32 v122, s27, v122
  v_mfma_f32_16x16x32_bf16 v[148:151], a[148:151], v[80:83], 0
  s_or_b64 s[30:31], s[30:31], vcc
  v_exp_f32 v121, v121
  v_exp_f32 v122, v122
  v_mfma_f32_16x16x32_bf16 v[180:183], a[148:151], v[84:87], 0
  s_cmp_lg_u64 s[30:31], 0
  s_addc_u32 s28, s28, s28
  v_cvt_pk_bf16_f32 v92, v120, v121
  v_mul_f32 v123, s27, v123
  v_mfma_f32_16x16x32_bf16 a[228:231], a[240:243], v[84:87], 0
  s_waitcnt lgkmcnt(8)
  ds_write_b128 v35, v[216:219] offset:128
  v_exp_f32 v123, v123
  v_mfma_f32_16x16x32_bf16 v[152:155], a[152:155], v[80:83], 0
  s_mov_b64 s[30:31], 0
  ds_read_b128 a[112:115], v16 offset:12288
  v_mul_f32 v124, s27, v124
  v_mfma_f32_16x16x32_bf16 v[184:187], a[152:155], v[84:87], 0
  s_waitcnt lgkmcnt(8)
  v_cvt_pk_bf16_f32 v93, v122, v123
  v_mul_f32 v125, s27, v125
  v_exp_f32 v124, v124
  v_mfma_f32_16x16x32_bf16 v[156:159], a[156:159], v[80:83], 0
  s_mov_b64 vcc, 0
  ds_write_b128 v34, v[224:227] offset:4096
  v_mfma_f32_16x16x32_bf16 v[188:191], a[156:159], v[84:87], 0
  s_waitcnt lgkmcnt(8)
  ds_read_b128 a[116:119], v17 offset:12288
  v_exp_f32 v125, v125
L_it1:
  v_mfma_f32_16x16x32_bf16 v[96:99], a[96:99], a[0:3], 0
  s_waitcnt lgkmcnt(4)
  v_mul_f32 v126, s27, v126
  v_cvt_pk_bf16_f32 v94, v124, v125
  v_mfma_f32_16x16x32_bf16 v[96:99], a[100:103], a[4:7], v[96:99]
  s_waitcnt lgkmcnt(3)
  ds_write_b128 v35, v[232:235] offset:4096
  v_mfma_f32_16x16x32_bf16 v[96:99], a[104:107], a[8:11], v[96:99]
  s_waitcnt lgkmcnt(3)
  ds_read_b128 a[120:123], v18 offset:12288
  v_mul_f32 v127, s27, v127
  v_mfma_f32_16x16x32_bf16 v[96:99], a[108:111], a[12:15], v[96:99]
  v_exp_f32 v126, v126
  v_mfma_f32_16x16x32_bf16 v[104:107], a[108:111], a[28:31], 0
  ds_read_b128 a[124:127], v19 offset:12288
  v_mul_f32 v116, s27, v116
  v_mfma_f32_16x16x32_bf16 v[104:107], a[104:107], a[24:27], v[104:107]
  v_exp_f32 v127, v127
  v_mfma_f32_16x16x32_bf16 v[104:107], a[100:103], a[20:23], v[104:107]
  s_add_u32 m0, s29, 0
  v_cvt_pk_bf16_f32 v95, v126, v127
  v_mul_f32 v117, s27, v117
  v_mfma_f32_16x16x32_bf16 v[104:107], a[96:99], a[16:19], v[104:107]
  s_waitcnt lgkmcnt(4)
  ds_write_b128 v34, v[240:243] offset:4224
  v_mfma_f32_16x16x32_bf16 v[108:111], a[112:115], a[16:19], 0
  s_waitcnt lgkmcnt(4)
  v_exp_f32 v116, v116
  v_mfma_f32_16x16x32_bf16 v[108:111], a[116:119], a[20:23], v[108:111]
  s_waitcnt lgkmcnt(2)
  buffer_load_dwordx4 v28, s[8:11], s21 offen offset:0 nt lds
  v_mfma_f32_16x16x32_bf16 v[108:111], a[120:123], a[24:27], v[108:111]
  s_waitcnt lgkmcnt(1)
  v_exp_f32 v117, v117
  v_mul_f32 v118, s27, v118
  v_mfma_f32_16x16x32_bf16 v[108:111], a[124:127], a[28:31], v[108:111]
  v_cvt_pk_bf16_f32 v90, v116, v117
  v_mul_f32 v119, s27, v119
  v_mfma_f32_16x16x32_bf16 v[100:103], a[124:127], a[12:15], 0
  ds_write_b128 v35, v[248:251] offset:4224
  v_exp_f32 v118, v118
  v_mfma_f32_16x16x32_bf16 v[100:103], a[120:123], a[8:11], v[100:103]
  v_exp_f32 v119, v119
  v_mfma_f32_16x16x32_bf16 v[100:103], a[116:119], a[4:7], v[100:103]
  v_cvt_pk_bf16_f32 v91, v118, v119
  v_mul_f32 v96, s27, v96
  v_mfma_f32_16x16x32_bf16 v[100:103], a[112:115], a[0:3], v[100:103]
  v_exp_f32 v96, v96
  v_mfma_f32_16x16x32_bf16 v[192:195], a[128:131], v[88:91], 0
  ds_read_b64 a[192:193], v8 offset:0
  v_mul_f32 v97, s27, v97
  v_mfma_f32_16x16x32_bf16 v[224:227], a[128:131], v[92:95], 0
  buffer_load_dwordx4 v29, s[8:11], s21 offen offset:1024 nt lds
  v_mfma_f32_16x16x32_bf16 v[196:199], a[132:135], v[88:91], 0
  s_add_u32 s29, s29, 8192
  v_exp_f32 v97, v97
  v_mfma_f32_16x16x32_bf16 v[228:231], a[132:135], v[92:95], 0
  s_and_b32 s29, s29, 0xffff
  ds_read_b64_tr_b16 a[128:129], v20 offset:8192
  v_mul_f32 v98, s27, v98
  v_mfma_f32_16x16x32_bf16 v[200:203], a[136:139], v[88:91], 0
  s_add_u32 s55, s55, 2048
  ds_read_b64 a[194:195], v9 offset:0
  v_cvt_pk_bf16_f32 v80, v96, v97
  v_mfma_f32_16x16x32_bf16 v[232:235], a[136:139], v[92:95], 0
  s_and_b32 s55, s55, 32767
  v_exp_f32 v98, v98
  v_mfma_f32_16x16x32_bf16 a[232:235], a[240:243], v[88:91], 0
  s_add_u32 s21, s80, s55
  ds_read_b64 a[196:197], v10 offset:1024
  ds_read_b64_tr_b16 a[130:131], v20 offset:12288
  v_mul_f32 v99, s27, v99
  v_mfma_f32_16x16x32_bf16 v[204:207], a[140:143], v[88:91], 0
  v_exp_f32 v99, v99
  v_mfma_f32_16x16x32_bf16 v[236:239], a[140:143], v[92:95], 0
  s_add_u32 m0, s49, 65536
  ds_read_b64 a[198:199], v11 offset:1024
  v_mul_f32 v104, s27, v104
  v_cvt_pk_bf16_f32 v81, v98, v99
  v_mfma_f32_16x16x32_bf16 v[208:211], a[144:147], v[88:91], 0
  buffer_load_dwordx4 v28, s[12:15], s22 offen offset:0 nt lds
  v_mfma_f32_16x16x32_bf16 v[240:243], a[144:147], v[92:95], 0
  ds_read_b64_tr_b16 a[132:133], v21 offset:8192
  ds_read_b64 a[200:201], v8 offset:2048
  v_mul_f32 v105, s27, v105
  v_mfma_f32_16x16x32_bf16 v[212:215], a[148:151], v[88:91], 0
  ds_read_b64_tr_b16 a[134:135], v21 offset:12288
  v_exp_f32 v104, v104
  v_mfma_f32_16x16x32_bf16 v[244:247], a[148:151], v[92:95], 0
  v_exp_f32 v105, v105
  v_mul_f32 v106, s27, v106
  v_mfma_f32_16x16x32_bf16 a[236:239], a[240:243], v[92:95], 0
  ds_read_b64 a[202:203], v9 offset:2048
  v_cvt_pk_bf16_f32 v84, v104, v105
  v_mfma_f32_16x16x32_bf16 v[216:219], a[152:155], v[88:91], 0
  ds_read_b64_tr_b16 a[136:137], v22 offset:8192
  v_exp_f32 v106, v106
  v_mfma_f32_16x16x32_bf16 v[248:251], a[152:155], v[92:95], 0
  ds_read_b64 a[204:205], v10 offset:3072
  v_mul_f32 v107, s27, v107
  v_mfma_f32_16x16x32_bf16 v[220:223], a[156:159], v[88:91], 0
  v_exp_f32 v107, v107
  v_mul_f32 v108, s27, v108
  v_mfma_f32_16x16x32_bf16 v[252:255], a[156:159], v[92:95], 0
  buffer_load_dwordx4 v29, s[12:15], s22 offen offset:1024 nt lds
  v_mfma_f32_16x16x32_bf16 v[112:115], a[96:99], a[32:35], 0
  s_add_u32 s49, s49, 8192
  ds_read_b64 a[206:207], v11 offset:3072
  ds_read_b64_tr_b16 a[138:139], v22 offset:12288
  v_cvt_pk_bf16_f32 v85, v106, v107
  v_mfma_f32_16x16x32_bf16 v[112:115], a[100:103], a[36:39], v[112:115]
  s_and_b32 s49, s49, 0xffff
  v_exp_f32 v108, v108
  v_mul_f32 v109, s27, v109
  v_mfma_f32_16x16x32_bf16 v[112:115], a[104:107], a[40:43], v[112:115]
  s_add_u32 s56, s56, 2048
  ds_read_b64 a[208:209], v8 offset:4096
  ds_read_b64_tr_b16 a[140:141], v23 offset:8192
  v_mul_f32 v110, s27, v110
  v_mfma_f32_16x16x32_bf16 v[112:115], a[108:111], a[44:47], v[112:115]
  s_and_b32 s56, s56, 32767
  ds_read_b64 a[210:211], v9 offset:4096
  v_exp_f32 v109, v109
  v_mfma_f32_16x16x32_bf16 v[120:123], a[108:111], a[60:63], 0
  s_add_u32 s22, s81, s56
  ds_read_b64_tr_b16 a[142:143], v23 offset:12288
  v_cvt_pk_bf16_f32 v86, v108, v109
  v_mul_f32 v111, s27, v111
  v_mfma_f32_16x16x32_bf16 v[120:123], a[104:107], a[56:59], v[120:123]
  ds_read_b64 a[212:213], v10 offset:5120
  v_exp_f32 v110, v110
  v_mfma_f32_16x16x32_bf16 v[120:123], a[100:103], a[52:55], v[120:123]
  ds_read_b64_tr_b16 a[144:145], v24 offset:8192
  v_exp_f32 v111, v111
  v_mfma_f32_16x16x32_bf16 v[120:123], a[96:99], a[48:51], v[120:123]
  ds_read_b64 a[214:215], v11 offset:5120
  v_mul_f32 v100, s27, v100
  v_cvt_pk_bf16_f32 v87, v110, v111
  v_mfma_f32_16x16x32_bf16 v[124:127], a[112:115], a[48:51], 0
  v_exp_f32 v100, v100
  v_mul_f32 v101, s27, v101
  v_mfma_f32_16x16x32_bf16 v[124:127], a[116:119], a[52:55], v[124:127]
  ds_read_b64 a[216:217], v8 offset:6144
  ds_read_b64_tr_b16 a[146:147], v24 offset:12288
  v_mfma_f32_16x16x32_bf16 v[124:127], a[120:123], a[56:59], v[124:127]
  v_exp_f32 v101, v101
  v_mul_f32 v102, s27, v102
  v_mfma_f32_16x16x32_bf16 v[124:127], a[124:127], a[60:63], v[124:127]
  ds_read_b64 a[218:219], v9 offset:6144
  ds_read_b64_tr_b16 a[148:149], v25 offset:8192
  v_cvt_pk_bf16_f32 v82, v100, v101
  v_mfma_f32_16x16x32_bf16 v[116:119], a[124:127], a[44:47], 0
  ds_read_b64 a[220:221], v10 offset:7168
  v_mul_f32 v103, s27, v103
  v_exp_f32 v102, v102
  v_mfma_f32_16x16x32_bf16 v[116:119], a[120:123], a[40:43], v[116:119]
  ds_read_b64_tr_b16 a[150:151], v25 offset:12288
  v_exp_f32 v103, v103
  v_mfma_f32_16x16x32_bf16 v[116:119], a[116:119], a[36:39], v[116:119]
  ds_read_b64 a[222:223], v11 offset:7168
  v_cvt_pk_bf16_f32 v83, v102, v103
  v_mfma_f32_16x16x32_bf16 v[116:119], a[112:115], a[32:35], v[116:119]
  s_waitcnt lgkmcnt(15)
  ds_read_b64_tr_b16 a[152:153], v26 offset:8192
  v_mul_f32 v112, s27, v112
  v_mfma_f32_16x16x32_bf16 v[128:131], a[128:131], v[80:83], v[128:131]
  buffer_store_dwordx4 a[160:163], v40, s[16:19], s72 offen offset:0 nt
  v_exp_f32 v112, v112
  v_mul_f32 v113, s27, v113
  v_mfma_f32_16x16x32_bf16 v[160:163], a[128:131], v[84:87], v[160:163]
  ds_read_b64_tr_b16 a[154:155], v26 offset:12288
  v_mul_f32 v114, s27, v114
  v_mfma_f32_16x16x32_bf16 v[132:135], a[132:135], v[80:83], v[132:135]
  v_exp_f32 v113, v113
  v_mfma_f32_16x16x32_bf16 v[164:167], a[132:135], v[84:87], v[164:167]
  s_waitcnt lgkmcnt(15)
  ds_read_b64_tr_b16 a[156:157], v27 offset:8192
  v_cvt_pk_bf16_f32 v88, v112, v113
  v_mfma_f32_16x16x32_bf16 v[136:139], a[136:139], v[80:83], v[136:139]
  buffer_store_dwordx4 a[164:167], v40, s[16:19], s72 offen offset:1024 nt
  ds_read_b128 a[96:99], v16 offset:16384
  v_exp_f32 v114, v114
  v_mfma_f32_16x16x32_bf16 v[168:171], a[136:139], v[84:87], v[168:171]
  ds_read_b64_tr_b16 a[158:159], v27 offset:12288
  v_mul_f32 v115, s27, v115
  v_mfma_f32_16x16x32_bf16 a[224:227], a[240:243], v[80:83], a[224:227]
  s_waitcnt lgkmcnt(15)
  v_exp_f32 v115, v115
  v_mfma_f32_16x16x32_bf16 v[140:143], a[140:143], v[80:83], v[140:143]
  v_mul_f32 v120, s27, v120
  v_cvt_pk_bf16_f32 v89, v114, v115
  v_mfma_f32_16x16x32_bf16 v[172:175], a[140:143], v[84:87], v[172:175]
  s_waitcnt lgkmcnt(10)
  ds_read_b128 a[100:103], v17 offset:16384
  v_mul_f32 v121, s27, v121
  v_mfma_f32_16x16x32_bf16 v[144:147], a[144:147], v[80:83], v[144:147]
  v_exp_f32 v120, v120
  v_mfma_f32_16x16x32_bf16 v[176:179], a[144:147], v[84:87], v[176:179]
  s_waitcnt lgkmcnt(7)
  ds_read_b128 a[104:107], v18 offset:16384
  v_mul_f32 v122, s27, v122
  v_mfma_f32_16x16x32_bf16 v[148:151], a[148:151], v[80:83], v[148:151]
  v_exp_f32 v121, v121
  v_mfma_f32_16x16x32_bf16 v[180:183], a[148:151], v[84:87], v[180:183]
  ds_read_b128 a[108:111], v19 offset:16384
  v_cvt_pk_bf16_f32 v92, v120, v121
  v_mfma_f32_16x16x32_bf16 a[228:231], a[240:243], v[84:87], a[228:231]
  s_waitcnt lgkmcnt(6)
  v_exp_f32 v122, v122
  v_mfma_f32_16x16x32_bf16 v[152:155], a[152:155], v[80:83], v[152:155]
  ds_read_b128 a[112:115], v16 offset:20480
  v_mul_f32 v123, s27, v123
  v_exp_f32 v123, v123
  v_mfma_f32_16x16x32_bf16 v[184:187], a[152:155], v[84:87], v[184:187]
  s_waitcnt lgkmcnt(4)
  v_mul_f32 v124, s27, v124
  v_cvt_pk_bf16_f32 v93, v122, v123
  v_mfma_f32_16x16x32_bf16 v[156:159], a[156:159], v[80:83], v[156:159]
  v_exp_f32 v124, v124
  v_mul_f32 v125, s27, v125
  v_mfma_f32_16x16x32_bf16 v[188:191], a[156:159], v[84:87], v[188:191]
  s_waitcnt lgkmcnt(0)
  ds_read_b128 a[116:119], v17 offset:20480
  v_exp_f32 v125, v125
  v_mfma_f32_16x16x32_bf16 v[96:99], a[96:99], a[0:3], 0
  v_mul_f32 v126, s27, v126
  v_cvt_pk_bf16_f32 v94, v124, v125
  v_mfma_f32_16x16x32_bf16 v[96:99], a[100:103], a[4:7], v[96:99]
  ds_read_b128 a[120:123], v18 offset:20480
  v_mul_f32 v127, s27, v127
  v_mfma_f32_16x16x32_bf16 v[96:99], a[104:107], a[8:11], v[96:99]
  v_exp_f32 v126, v126
  v_mfma_f32_16x16x32_bf16 v[96:99], a[108:111], a[12:15], v[96:99]
  v_exp_f32 v127, v127
  v_mfma_f32_16x16x32_bf16 v[104:107], a[108:111], a[28:31], 0
  ds_read_b128 a[124:127], v19 offset:20480
  v_mul_f32 v116, s27, v116
  v_mfma_f32_16x16x32_bf16 v[104:107], a[104:107], a[24:27], v[104:107]
  v_cvt_pk_bf16_f32 v95, v126, v127
  v_mul_f32 v117, s27, v117
  v_mfma_f32_16x16x32_bf16 v[104:107], a[100:103], a[20:23], v[104:107]
  v_exp_f32 v116, v116
  v_mfma_f32_16x16x32_bf16 v[104:107], a[96:99], a[16:19], v[104:107]
  v_exp_f32 v117, v117
  v_mfma_f32_16x16x32_bf16 v[108:111], a[112:115], a[16:19], 0
  s_waitcnt lgkmcnt(2)
  v_mul_f32 v118, s27, v118
  v_cvt_pk_bf16_f32 v90, v116, v117
  v_mfma_f32_16x16x32_bf16 v[108:111], a[116:119], a[20:23], v[108:111]
  s_waitcnt lgkmcnt(1)
  v_exp_f32 v118, v118
  v_mfma_f32_16x16x32_bf16 v[108:111], a[120:123], a[24:27], v[108:111]
  s_waitcnt lgkmcnt(0)
  v_mul_f32 v119, s27, v119
  v_mul_f32 v96, s27, v96
  v_mfma_f32_16x16x32_bf16 v[108:111], a[124:127], a[28:31], v[108:111]
  v_exp_f32 v119, v119
  v_mfma_f32_16x16x32_bf16 v[100:103], a[124:127], a[12:15], 0
  s_cbranch_vccnz L_ramp2A
L_back2:
  v_cvt_pk_bf16_f32 v91, v118, v119
  v_mul_f32 v97, s27, v97
  v_mfma_f32_16x16x32_bf16 v[100:103], a[120:123], a[8:11], v[100:103]
  s_waitcnt vmcnt(12)
  v_exp_f32 v96, v96
  v_mfma_f32_16x16x32_bf16 v[100:103], a[116:119], a[4:7], v[100:103]
  s_barrier
  v_exp_f32 v97, v97
  v_mfma_f32_16x16x32_bf16 v[100:103], a[112:115], a[0:3], v[100:103]
  v_mul_f32 v98, s27, v98
  v_cvt_pk_bf16_f32 v80, v96, v97
  v_mfma_f32_16x16x32_bf16 v[192:195], a[128:131], v[88:91], v[192:195]
  s_add_u32 m0, s29, 0
  v_exp_f32 v98, v98
  v_mfma_f32_16x16x32_bf16 v[224:227], a[128:131], v[92:95], v[224:227]
  buffer_load_dwordx4 v28, s[8:11], s21 offen offset:0 nt lds
  v_mfma_f32_16x16x32_bf16 v[196:199], a[132:135], v[88:91], v[196:199]
  ds_read_b64_tr_b16 a[128:129], v20 offset:16384
  v_mul_f32 v99, s27, v99
  v_mfma_f32_16x16x32_bf16 v[228:231], a[132:135], v[92:95], v[228:231]
  ds_read_b64_tr_b16 a[130:131], v20 offset:20480
  v_mul_f32 v104, s27, v104
  v_mfma_f32_16x16x32_bf16 v[200:203], a[136:139], v[88:91], v[200:203]
  v_exp_f32 v99, v99
  v_mfma_f32_16x16x32_bf16 v[232:235], a[136:139], v[92:95], v[232:235]
  ds_read_b64_tr_b16 a[132:133], v21 offset:16384
  v_cvt_pk_bf16_f32 v81, v98, v99
  v_mfma_f32_16x16x32_bf16 a[232:235], a[240:243], v[88:91], a[232:235]
  v_exp_f32 v104, v104
  v_mfma_f32_16x16x32_bf16 v[204:207], a[140:143], v[88:91], v[204:207]
  ds_read_b64_tr_b16 a[134:135], v21 offset:20480
  v_mul_f32 v105, s27, v105
  v_mfma_f32_16x16x32_bf16 v[236:239], a[140:143], v[92:95], v[236:239]
  v_exp_f32 v105, v105
  v_mfma_f32_16x16x32_bf16 v[208:211], a[144:147], v[88:91], v[208:211]
  buffer_load_dwordx4 v29, s[8:11], s21 offen offset:1024 nt lds
  v_mfma_f32_16x16x32_bf16 v[240:243], a[144:147], v[92:95], v[240:243]
  s_add_u32 s29, s29, 8192
  v_mul_f32 v106, s27, v106
  v_cvt_pk_bf16_f32 v84, v104, v105
  v_mfma_f32_16x16x32_bf16 v[212:215], a[148:151], v[88:91], v[212:215]
  s_and_b32 s29, s29, 0xffff
  v_exp_f32 v106, v106
  v_mfma_f32_16x16x32_bf16 v[244:247], a[148:151], v[92:95], v[244:247]
  s_add_u32 s55, s55, 2048
  ds_read_b64_tr_b16 a[136:137], v22 offset:16384
  v_mul_f32 v107, s27, v107
  v_mfma_f32_16x16x32_bf16 a[236:239], a[240:243], v[92:95], a[236:239]
  s_and_b32 s55, s55, 32767
  v_exp_f32 v107, v107
  v_mfma_f32_16x16x32_bf16 v[216:219], a[152:155], v[88:91], v[216:219]
  s_add_u32 s21, s80, s55
  v_mul_f32 v108, s27, v108
  v_cvt_pk_bf16_f32 v85, v106, v107
  v_mfma_f32_16x16x32_bf16 v[248:251], a[152:155], v[92:95], v[248:251]
  ds_read_b64_tr_b16 a[138:139], v22 offset:20480
  v_mul_f32 v109, s27, v109
  v_mfma_f32_16x16x32_bf16 v[220:223], a[156:159], v[88:91], v[220:223]
  s_add_u32 m0, s49, 65536
  v_exp_f32 v108, v108
  v_mfma_f32_16x16x32_bf16 v[252:255], a[156:159], v[92:95], v[252:255]
  buffer_load_dwordx4 v28, s[12:15], s22 offen offset:0 nt lds
  v_mfma_f32_16x16x32_bf16 v[112:115], a[96:99], a[32:35], 0
  ds_read_b64_tr_b16 a[140:141], v23 offset:16384
  v_mul_f32 v110, s27, v110
  v_mfma_f32_16x16x32_bf16 v[112:115], a[100:103], a[36:39], v[112:115]
  v_exp_f32 v109, v109
  v_mfma_f32_16x16x32_bf16 v[112:115], a[104:107], a[40:43], v[112:115]
  ds_read_b64_tr_b16 a[142:143], v23 offset:20480
  v_cvt_pk_bf16_f32 v86, v108, v109
  v_mfma_f32_16x16x32_bf16 v[112:115], a[108:111], a[44:47], v[112:115]
  v_exp_f32 v110, v110
  v_mfma_f32_16x16x32_bf16 v[120:123], a[108:111], a[60:63], 0
  ds_read_b64_tr_b16 a[144:145], v24 offset:16384
  v_mul_f32 v111, s27, v111
  v_mfma_f32_16x16x32_bf16 v[120:123], a[104:107], a[56:59], v[120:123]
  v_exp_f32 v111, v111
  v_mfma_f32_16x16x32_bf16 v[120:123], a[100:103], a[52:55], v[120:123]
  v_mul_f32 v100, s27, v100
  v_cvt_pk_bf16_f32 v87, v110, v111
  v_mfma_f32_16x16x32_bf16 v[120:123], a[96:99], a[48:51], v[120:123]
  buffer_load_dwordx4 v29, s[12:15], s22 offen offset:1024 nt lds
  v_mfma_f32_16x16x32_bf16 v[124:127], a[112:115], a[48:51], 0
  s_add_u32 s49, s49, 8192
  v_exp_f32 v100, v100
  v_mul_f32 v101, s27, v101
  v_mfma_f32_16x16x32_bf16 v[124:127], a[116:119], a[52:55], v[124:127]
  s_and_b32 s49, s49, 0xffff
  ds_read_b64_tr_b16 a[146:147], v24 offset:20480
  v_mul_f32 v102, s27, v102
  v_mfma_f32_16x16x32_bf16 v[124:127], a[120:123], a[56:59], v[124:127]
  s_add_u32 s56, s56, 2048
  v_exp_f32 v101, v101
  v_mfma_f32_16x16x32_bf16 v[124:127], a[124:127], a[60:63], v[124:127]
  s_and_b32 s56, s56, 32767
  ds_read_b64_tr_b16 a[148:149], v25 offset:16384
  v_cvt_pk_bf16_f32 v82, v100, v101
  v_mfma_f32_16x16x32_bf16 v[116:119], a[124:127], a[44:47], 0
  s_add_u32 s22, s81, s56
  ds_read_b64_tr_b16 a[150:151], v25 offset:20480
  v_mul_f32 v103, s27, v103
  v_exp_f32 v102, v102
  v_mfma_f32_16x16x32_bf16 v[116:119], a[120:123], a[40:43], v[116:119]
  v_exp_f32 v103, v103
  v_mfma_f32_16x16x32_bf16 v[116:119], a[116:119], a[36:39], v[116:119]
  ds_read_b64_tr_b16 a[152:153], v26 offset:16384
  v_cvt_pk_bf16_f32 v83, v102, v103
  v_mfma_f32_16x16x32_bf16 v[116:119], a[112:115], a[32:35], v[116:119]
  s_waitcnt lgkmcnt(11)
  v_mul_f32 v112, s27, v112
  v_mul_f32 v113, s27, v113
  v_mfma_f32_16x16x32_bf16 v[128:131], a[128:131], v[80:83], v[128:131]
  s_add_u32 m0, s44, 0
  v_exp_f32 v112, v112
  v_mfma_f32_16x16x32_bf16 v[160:163], a[128:131], v[84:87], v[160:163]
  s_waitcnt lgkmcnt(9)
  ds_read_b64_tr_b16 a[154:155], v26 offset:20480
  v_mul_f32 v114, s27, v114
  v_mfma_f32_16x16x32_bf16 v[132:135], a[132:135], v[80:83], v[132:135]
  buffer_load_dwordx4 v28, s[4:7], s68 offen offset:0 nt lds
  v_mfma_f32_16x16x32_bf16 v[164:167], a[132:135], v[84:87], v[164:167]
  s_waitcnt lgkmcnt(8)
  v_exp_f32 v113, v113
  v_mfma_f32_16x16x32_bf16 v[136:139], a[136:139], v[80:83], v[136:139]
  ds_read_b64_tr_b16 a[156:157], v27 offset:16384
  v_cvt_pk_bf16_f32 v88, v112, v113
  v_mfma_f32_16x16x32_bf16 v[168:171], a[136:139], v[84:87], v[168:171]
  v_exp_f32 v114, v114
  v_mfma_f32_16x16x32_bf16 a[224:227], a[240:243], v[80:83], a[224:227]
  s_waitcnt lgkmcnt(7)
  ds_read_b128 a[96:99], v16 offset:24576
  v_mul_f32 v115, s27, v115
  v_mfma_f32_16x16x32_bf16 v[140:143], a[140:143], v[80:83], v[140:143]
  ds_read_b64_tr_b16 a[158:159], v27 offset:20480
  v_exp_f32 v115, v115
  v_mfma_f32_16x16x32_bf16 v[172:175], a[140:143], v[84:87], v[172:175]
  s_waitcnt lgkmcnt(7)
  ds_read_b128 a[100:103], v17 offset:24576
  v_mul_f32 v120, s27, v120
  v_cvt_pk_bf16_f32 v89, v114, v115
  v_mfma_f32_16x16x32_bf16 v[144:147], a[144:147], v[80:83], v[144:147]
  v_exp_f32 v120, v120
  v_mfma_f32_16x16x32_bf16 v[176:179], a[144:147], v[84:87], v[176:179]
  s_waitcnt lgkmcnt(6)
  buffer_load_dwordx4 v29, s[4:7], s68 offen offset:1024 nt lds
  v_mfma_f32_16x16x32_bf16 v[148:151], a[148:151], v[80:83], v[148:151]
  ds_read_b128 a[104:107], v18 offset:24576
  ds_read_b128 a[108:111], v19 offset:24576
  v_mul_f32 v121, s27, v121
  v_mfma_f32_16x16x32_bf16 v[180:183], a[148:151], v[84:87], v[180:183]
  v_exp_f32 v121, v121
  v_mul_f32 v122, s27, v122
  v_mfma_f32_16x16x32_bf16 a[228:231], a[240:243], v[84:87], a[228:231]
  s_waitcnt lgkmcnt(6)
  v_cvt_pk_bf16_f32 v92, v120, v121
  v_mul_f32 v123, s27, v123
  v_exp_f32 v122, v122
  v_mfma_f32_16x16x32_bf16 v[152:155], a[152:155], v[80:83], v[152:155]
  v_exp_f32 v123, v123
  v_mfma_f32_16x16x32_bf16 v[184:187], a[152:155], v[84:87], v[184:187]
  s_waitcnt lgkmcnt(3)
  ds_read_b128 a[112:115], v16 offset:28672
  v_mul_f32 v124, s27, v124
  v_cvt_pk_bf16_f32 v93, v122, v123
  v_mfma_f32_16x16x32_bf16 v[156:159], a[156:159], v[80:83], v[156:159]
  v_exp_f32 v124, v124
  v_mul_f32 v125, s27, v125
  v_mfma_f32_16x16x32_bf16 v[188:191], a[156:159], v[84:87], v[188:191]
  ds_read_b128 a[116:119], v17 offset:28672
  v_exp_f32 v125, v125
  v_mfma_f32_16x16x32_bf16 v[96:99], a[96:99], a[0:3], 0
  s_waitcnt lgkmcnt(4)
  v_mul_f32 v126, s27, v126
  v_cvt_pk_bf16_f32 v94, v124, v125
  v_mfma_f32_16x16x32_bf16 v[96:99], a[100:103], a[4:7], v[96:99]
  s_waitcnt lgkmcnt(3)
  ds_read_b128 a[120:123], v18 offset:28672
  v_mul_f32 v127, s27, v127
  v_mfma_f32_16x16x32_bf16 v[96:99], a[104:107], a[8:11], v[96:99]
  s_waitcnt lgkmcnt(3)
  v_exp_f32 v126, v126
  v_mfma_f32_16x16x32_bf16 v[96:99], a[108:111], a[12:15], v[96:99]
  v_exp_f32 v127, v127
  v_mfma_f32_16x16x32_bf16 v[104:107], a[108:111], a[28:31], 0
  ds_read_b128 a[124:127], v19 offset:28672
  v_mul_f32 v116, s27, v116
  v_mfma_f32_16x16x32_bf16 v[104:107], a[104:107], a[24:27], v[104:107]
  v_cvt_pk_bf16_f32 v95, v126, v127
  v_mul_f32 v117, s27, v117
  v_mfma_f32_16x16x32_bf16 v[104:107], a[100:103], a[20:23], v[104:107]
  s_add_u32 m0, s29, 0
  v_exp_f32 v116, v116
  v_mfma_f32_16x16x32_bf16 v[104:107], a[96:99], a[16:19], v[104:107]
  s_waitcnt lgkmcnt(3)
  v_exp_f32 v117, v117
  v_mfma_f32_16x16x32_bf16 v[108:111], a[112:115], a[16:19], 0
  s_waitcnt lgkmcnt(2)
  v_mul_f32 v118, s27, v118
  v_cvt_pk_bf16_f32 v90, v116, v117
  v_mfma_f32_16x16x32_bf16 v[108:111], a[116:119], a[20:23], v[108:111]
  s_waitcnt lgkmcnt(1)
  buffer_load_dwordx4 v28, s[8:11], s21 offen offset:0 nt lds
  v_mfma_f32_16x16x32_bf16 v[108:111], a[120:123], a[24:27], v[108:111]
  s_waitcnt lgkmcnt(0)
  v_exp_f32 v118, v118
  v_mfma_f32_16x16x32_bf16 v[108:111], a[124:127], a[28:31], v[108:111]
  v_mul_f32 v119, s27, v119
  v_mul_f32 v96, s27, v96
  v_mfma_f32_16x16x32_bf16 v[100:103], a[124:127], a[12:15], 0
  v_exp_f32 v119, v119
  v_mfma_f32_16x16x32_bf16 v[100:103], a[120:123], a[8:11], v[100:103]
  v_cvt_pk_bf16_f32 v91, v118, v119
  v_mul_f32 v97, s27, v97
  v_mfma_f32_16x16x32_bf16 v[100:103], a[116:119], a[4:7], v[100:103]
  v_exp_f32 v96, v96
  v_mfma_f32_16x16x32_bf16 v[100:103], a[112:115], a[0:3], v[100:103]
  v_exp_f32 v97, v97
  v_mfma_f32_16x16x32_bf16 v[192:195], a[128:131], v[88:91], v[192:195]
  v_mul_f32 v98, s27, v98
  v_cvt_pk_bf16_f32 v80, v96, v97
  v_mfma_f32_16x16x32_bf16 v[224:227], a[128:131], v[92:95], v[224:227]
  buffer_load_dwordx4 v29, s[8:11], s21 offen offset:1024 nt lds
  v_mfma_f32_16x16x32_bf16 v[196:199], a[132:135], v[88:91], v[196:199]
  s_add_u32 s29, s29, 8192
  ds_read_b64_tr_b16 a[128:129], v20 offset:24576
  v_mul_f32 v99, s27, v99
  v_mfma_f32_16x16x32_bf16 v[228:231], a[132:135], v[92:95], v[228:231]
  s_and_b32 s29, s29, 0xffff
  v_exp_f32 v98, v98
  v_mfma_f32_16x16x32_bf16 v[200:203], a[136:139], v[88:91], v[200:203]
  s_add_u32 s55, s55, 2048
  ds_read_b64_tr_b16 a[130:131], v20 offset:28672
  v_mul_f32 v104, s27, v104
  v_mfma_f32_16x16x32_bf16 v[232:235], a[136:139], v[92:95], v[232:235]
  s_and_b32 s55, s55, 32767
  v_exp_f32 v99, v99
  v_mfma_f32_16x16x32_bf16 a[232:235], a[240:243], v[88:91], a[232:235]
  s_add_u32 s21, s80, s55
  ds_read_b64_tr_b16 a[132:133], v21 offset:24576
  v_cvt_pk_bf16_f32 v81, v98, v99
  v_mfma_f32_16x16x32_bf16 v[204:207], a[140:143], v[88:91], v[204:207]
  v_exp_f32 v104, v104
  v_mfma_f32_16x16x32_bf16 v[236:239], a[140:143], v[92:95], v[236:239]
  s_add_u32 m0, s49, 65536
  ds_read_b64_tr_b16 a[134:135], v21 offset:28672
  v_mul_f32 v105, s27, v105
  v_mfma_f32_16x16x32_bf16 v[208:211], a[144:147], v[88:91], v[208:211]
  buffer_load_dwordx4 v28, s[12:15], s22 offen offset:0 nt lds
  v_mfma_f32_16x16x32_bf16 v[240:243], a[144:147], v[92:95], v[240:243]
  v_exp_f32 v105, v105
  v_mfma_f32_16x16x32_bf16 v[212:215], a[148:151], v[88:91], v[212:215]
  v_mul_f32 v106, s27, v106
  v_cvt_pk_bf16_f32 v84, v104, v105
  v_mfma_f32_16x16x32_bf16 v[244:247], a[148:151], v[92:95], v[244:247]
  v_exp_f32 v106, v106
  v_mfma_f32_16x16x32_bf16 a[236:239], a[240:243], v[92:95], a[236:239]
  ds_read_b64_tr_b16 a[136:137], v22 offset:24576
  v_mul_f32 v107, s27, v107
  v_mfma_f32_16x16x32_bf16 v[216:219], a[152:155], v[88:91], v[216:219]
  v_exp_f32 v107, v107
  v_mfma_f32_16x16x32_bf16 v[248:251], a[152:155], v[92:95], v[248:251]
  v_mul_f32 v108, s27, v108
  v_cvt_pk_bf16_f32 v85, v106, v107
  v_mfma_f32_16x16x32_bf16 v[220:223], a[156:159], v[88:91], v[220:223]
  ds_read_b64_tr_b16 a[138:139], v22 offset:28672
  v_mul_f32 v109, s27, v109
  v_mfma_f32_16x16x32_bf16 v[252:255], a[156:159], v[92:95], v[252:255]
  buffer_load_dwordx4 v29, s[12:15], s22 offen offset:1024 nt lds
  v_mfma_f32_16x16x32_bf16 v[112:115], a[96:99], a[32:35], 0
  s_add_u32 s49, s49, 8192
  v_exp_f32 v108, v108
  v_mfma_f32_16x16x32_bf16 v[112:115], a[100:103], a[36:39], v[112:115]
  s_and_b32 s49, s49, 0xffff
  ds_read_b64_tr_b16 a[140:141], v23 offset:24576
  v_mul_f32 v110, s27, v110
  v_mfma_f32_16x16x32_bf16 v[112:115], a[104:107], a[40:43], v[112:115]
  s_add_u32 s56, s56, 2048
  v_exp_f32 v109, v109
  v_mfma_f32_16x16x32_bf16 v[112:115], a[108:111], a[44:47], v[112:115]
  s_and_b32 s56, s56, 32767
  ds_read_b64_tr_b16 a[142:143], v23 offset:28672
  v_cvt_pk_bf16_f32 v86, v108, v109
  v_mfma_f32_16x16x32_bf16 v[120:123], a[108:111], a[60:63], 0
  s_add_u32 s22, s81, s56
  v_exp_f32 v110, v110
  v_mul_f32 v111, s27, v111
  v_mfma_f32_16x16x32_bf16 v[120:123], a[104:107], a[56:59], v[120:123]
  v_exp_f32 v111, v111
  v_mfma_f32_16x16x32_bf16 v[120:123], a[100:103], a[52:55], v[120:123]
  ds_read_b64_tr_b16 a[144:145], v24 offset:24576
  v_mul_f32 v100, s27, v100
  v_cvt_pk_bf16_f32 v87, v110, v111
  v_mfma_f32_16x16x32_bf16 v[120:123], a[96:99], a[48:51], v[120:123]
  v_exp_f32 v100, v100
  v_mfma_f32_16x16x32_bf16 v[124:127], a[112:115], a[48:51], 0
  ds_read_b64_tr_b16 a[146:147], v24 offset:28672
  v_mul_f32 v101, s27, v101
  v_mfma_f32_16x16x32_bf16 v[124:127], a[116:119], a[52:55], v[124:127]
  v_exp_f32 v101, v101
  v_mfma_f32_16x16x32_bf16 v[124:127], a[120:123], a[56:59], v[124:127]
  v_mul_f32 v102, s27, v102
  v_cvt_pk_bf16_f32 v82, v100, v101
  v_mfma_f32_16x16x32_bf16 v[124:127], a[124:127], a[60:63], v[124:127]
  ds_read_b64_tr_b16 a[148:149], v25 offset:24576
  v_mul_f32 v103, s27, v103
  v_mfma_f32_16x16x32_bf16 v[116:119], a[124:127], a[44:47], 0
  v_exp_f32 v102, v102
  v_mfma_f32_16x16x32_bf16 v[116:119], a[120:123], a[40:43], v[116:119]
  ds_read_b64_tr_b16 a[150:151], v25 offset:28672
  v_exp_f32 v103, v103
  v_mfma_f32_16x16x32_bf16 v[116:119], a[116:119], a[36:39], v[116:119]
  ds_read_b64_tr_b16 a[152:153], v26 offset:24576
  v_cvt_pk_bf16_f32 v83, v102, v103
  v_mfma_f32_16x16x32_bf16 v[116:119], a[112:115], a[32:35], v[116:119]
  s_waitcnt lgkmcnt(11)
  v_mul_f32 v112, s27, v112
  v_mul_f32 v113, s27, v113
  v_mfma_f32_16x16x32_bf16 v[128:131], a[128:131], v[80:83], v[128:131]
  s_add_u32 m0, s44, 2048
  v_exp_f32 v112, v112
  v_mfma_f32_16x16x32_bf16 v[160:163], a[128:131], v[84:87], v[160:163]
  s_waitcnt lgkmcnt(9)
  ds_read_b64_tr_b16 a[154:155], v26 offset:28672
  v_mul_f32 v114, s27, v114
  v_mfma_f32_16x16x32_bf16 v[132:135], a[132:135], v[80:83], v[132:135]
  buffer_load_dwordx4 v28, s[4:7], s69 offen offset:0 nt lds
  v_mfma_f32_16x16x32_bf16 v[164:167], a[132:135], v[84:87], v[164:167]
  s_waitcnt lgkmcnt(8)
  v_exp_f32 v113, v113
  v_mfma_f32_16x16x32_bf16 v[136:139], a[136:139], v[80:83], v[136:139]
  ds_read_b64_tr_b16 a[156:157], v27 offset:24576
  v_cvt_pk_bf16_f32 v88, v112, v113
  v_mfma_f32_16x16x32_bf16 v[168:171], a[136:139], v[84:87], v[168:171]
  v_exp_f32 v114, v114
  v_mfma_f32_16x16x32_bf16 a[224:227], a[240:243], v[80:83], a[224:227]
  s_waitcnt lgkmcnt(7)
  ds_read_b128 a[96:99], v16 offset:32768
  v_mul_f32 v115, s27, v115
  v_mfma_f32_16x16x32_bf16 v[140:143], a[140:143], v[80:83], v[140:143]
  ds_read_b64_tr_b16 a[158:159], v27 offset:28672
  v_exp_f32 v115, v115
  v_mfma_f32_16x16x32_bf16 v[172:175], a[140:143], v[84:87], v[172:175]
  s_waitcnt lgkmcnt(7)
  ds_read_b128 a[100:103], v17 offset:32768
  v_mul_f32 v120, s27, v120
  v_cvt_pk_bf16_f32 v89, v114, v115
  v_mfma_f32_16x16x32_bf16 v[144:147], a[144:147], v[80:83], v[144:147]
  v_exp_f32 v120, v120
  v_mfma_f32_16x16x32_bf16 v[176:179], a[144:147], v[84:87], v[176:179]
  s_waitcnt lgkmcnt(6)
  buffer_load_dwordx4 v29, s[4:7], s69 offen offset:1024 nt lds
  v_mfma_f32_16x16x32_bf16 v[148:151], a[148:151], v[80:83], v[148:151]
  ds_read_b128 a[104:107], v18 offset:32768
  ds_read_b128 a[108:111], v19 offset:32768
  v_mul_f32 v121, s27, v121
  v_mfma_f32_16x16x32_bf16 v[180:183], a[148:151], v[84:87], v[180:183]
  v_exp_f32 v121, v121
  v_mul_f32 v122, s27, v122
  v_mfma_f32_16x16x32_bf16 a[228:231], a[240:243], v[84:87], a[228:231]
  s_waitcnt lgkmcnt(6)
  v_cvt_pk_bf16_f32 v92, v120, v121
  v_mul_f32 v123, s27, v123
  v_exp_f32 v122, v122
  v_mfma_f32_16x16x32_bf16 v[152:155], a[152:155], v[80:83], v[152:155]
  v_exp_f32 v123, v123
  v_mfma_f32_16x16x32_bf16 v[184:187], a[152:155], v[84:87], v[184:187]
  s_waitcnt lgkmcnt(3)
  ds_read_b128 a[112:115], v16 offset:36864
  v_mul_f32 v124, s27, v124
  v_cvt_pk_bf16_f32 v93, v122, v123
  v_mfma_f32_16x16x32_bf16 v[156:159], a[156:159], v[80:83], v[156:159]
  v_exp_f32 v124, v124
  v_mul_f32 v125, s27, v125
  v_mfma_f32_16x16x32_bf16 v[188:191], a[156:159], v[84:87], v[188:191]
  ds_read_b128 a[116:119], v17 offset:36864
  v_exp_f32 v125, v125
  v_mfma_f32_16x16x32_bf16 v[96:99], a[96:99], a[0:3], 0
  s_waitcnt lgkmcnt(4)
  v_mul_f32 v126, s27, v126
  v_cvt_pk_bf16_f32 v94, v124, v125
  v_mfma_f32_16x16x32_bf16 v[96:99], a[100:103], a[4:7], v[96:99]
  s_waitcnt lgkmcnt(3)
  ds_read_b128 a[120:123], v18 offset:36864
  v_mul_f32 v127, s27, v127
  v_mfma_f32_16x16x32_bf16 v[96:99], a[104:107], a[8:11], v[96:99]
  s_waitcnt lgkmcnt(3)
  v_exp_f32 v126, v126
  v_mfma_f32_16x16x32_bf16 v[96:99], a[108:111], a[12:15], v[96:99]
  v_exp_f32 v127, v127
  v_mfma_f32_16x16x32_bf16 v[104:107], a[108:111], a[28:31], 0
  ds_read_b128 a[124:127], v19 offset:36864
  v_mul_f32 v116, s27, v116
  v_mfma_f32_16x16x32_bf16 v[104:107], a[104:107], a[24:27], v[104:107]
  v_cvt_pk_bf16_f32 v95, v126, v127
  v_mul_f32 v117, s27, v117
  v_mfma_f32_16x16x32_bf16 v[104:107], a[100:103], a[20:23], v[104:107]
  v_exp_f32 v116, v116
  v_mfma_f32_16x16x32_bf16 v[104:107], a[96:99], a[16:19], v[104:107]
  s_waitcnt lgkmcnt(3)
  v_exp_f32 v117, v117
  v_mfma_f32_16x16x32_bf16 v[108:111], a[112:115], a[16:19], 0
  s_waitcnt lgkmcnt(2)
  v_mul_f32 v118, s27, v118
  v_cvt_pk_bf16_f32 v90, v116, v117
  v_mfma_f32_16x16x32_bf16 v[108:111], a[116:119], a[20:23], v[108:111]
  s_waitcnt lgkmcnt(1)
  v_exp_f32 v118, v118
  v_mfma_f32_16x16x32_bf16 v[108:111], a[120:123], a[24:27], v[108:111]
  s_waitcnt lgkmcnt(0)
  v_mul_f32 v119, s27, v119
  v_mul_f32 v96, s27, v96
  v_mfma_f32_16x16x32_bf16 v[108:111], a[124:127], a[28:31], v[108:111]
  v_exp_f32 v119, v119
  v_mfma_f32_16x16x32_bf16 v[100:103], a[124:127], a[12:15], 0
  s_cbranch_vccnz L_ramp4A
L_back4:
  v_cvt_pk_bf16_f32 v91, v118, v119
  v_mul_f32 v97, s27, v97
  v_mfma_f32_16x16x32_bf16 v[100:103], a[120:123], a[8:11], v[100:103]
  s_waitcnt vmcnt(14)
  v_exp_f32 v96, v96
  v_mfma_f32_16x16x32_bf16 v[100:103], a[116:119], a[4:7], v[100:103]
  s_barrier
  v_exp_f32 v97, v97
  v_mfma_f32_16x16x32_bf16 v[100:103], a[112:115], a[0:3], v[100:103]
  v_mul_f32 v98, s27, v98
  v_cvt_pk_bf16_f32 v80, v96, v97
  v_mfma_f32_16x16x32_bf16 v[192:195], a[128:131], v[88:91], v[192:195]
  s_add_u32 m0, s29, 0
  v_exp_f32 v98, v98
  v_mfma_f32_16x16x32_bf16 v[224:227], a[128:131], v[92:95], v[224:227]
  buffer_load_dwordx4 v28, s[8:11], s21 offen offset:0 nt lds
  v_mfma_f32_16x16x32_bf16 v[196:199], a[132:135], v[88:91], v[196:199]
  ds_read_b64_tr_b16 a[128:129], v20 offset:32768
  v_mul_f32 v99, s27, v99
  v_mfma_f32_16x16x32_bf16 v[228:231], a[132:135], v[92:95], v[228:231]
  ds_read_b64_tr_b16 a[130:131], v20 offset:36864
  v_mul_f32 v104, s27, v104
  v_mfma_f32_16x16x32_bf16 v[200:203], a[136:139], v[88:91], v[200:203]
  v_exp_f32 v99, v99
  v_mfma_f32_16x16x32_bf16 v[232:235], a[136:139], v[92:95], v[232:235]
  ds_read_b64_tr_b16 a[132:133], v21 offset:32768
  v_cvt_pk_bf16_f32 v81, v98, v99
  v_mfma_f32_16x16x32_bf16 a[232:235], a[240:243], v[88:91], a[232:235]
  v_exp_f32 v104, v104
  v_mfma_f32_16x16x32_bf16 v[204:207], a[140:143], v[88:91], v[204:207]
  ds_read_b64_tr_b16 a[134:135], v21 offset:36864
  v_mul_f32 v105, s27, v105
  v_mfma_f32_16x16x32_bf16 v[236:239], a[140:143], v[92:95], v[236:239]
  v_exp_f32 v105, v105
  v_mfma_f32_16x16x32_bf16 v[208:211], a[144:147], v[88:91], v[208:211]
  buffer_load_dwordx4 v29, s[8:11], s21 offen offset:1024 nt lds
  v_mfma_f32_16x16x32_bf16 v[240:243], a[144:147], v[92:95], v[240:243]
  s_add_u32 s29, s29, 8192
  v_mul_f32 v106, s27, v106
  v_cvt_pk_bf16_f32 v84, v104, v105
  v_mfma_f32_16x16x32_bf16 v[212:215], a[148:151], v[88:91], v[212:215]
  s_and_b32 s29, s29, 0xffff
  v_exp_f32 v106, v106
  v_mfma_f32_16x16x32_bf16 v[244:247], a[148:151], v[92:95], v[244:247]
  s_add_u32 s55, s55, 2048
  ds_read_b64_tr_b16 a[136:137], v22 offset:32768
  v_mul_f32 v107, s27, v107
  v_mfma_f32_16x16x32_bf16 a[236:239], a[240:243], v[92:95], a[236:239]
  s_and_b32 s55, s55, 32767
  v_exp_f32 v107, v107
  v_mfma_f32_16x16x32_bf16 v[216:219], a[152:155], v[88:91], v[216:219]
  s_add_u32 s21, s80, s55
  v_mul_f32 v108, s27, v108
  v_cvt_pk_bf16_f32 v85, v106, v107
  v_mfma_f32_16x16x32_bf16 v[248:251], a[152:155], v[92:95], v[248:251]
  ds_read_b64_tr_b16 a[138:139], v22 offset:36864
  v_mul_f32 v109, s27, v109
  v_mfma_f32_16x16x32_bf16 v[220:223], a[156:159], v[88:91], v[220:223]
  s_add_u32 m0, s49, 65536
  v_exp_f32 v108, v108
  v_mfma_f32_16x16x32_bf16 v[252:255], a[156:159], v[92:95], v[252:255]
  buffer_load_dwordx4 v28, s[12:15], s22 offen offset:0 nt lds
  v_mfma_f32_16x16x32_bf16 v[112:115], a[96:99], a[32:35], 0
  ds_read_b64_tr_b16 a[140:141], v23 offset:32768
  v_mul_f32 v110, s27, v110
  v_mfma_f32_16x16x32_bf16 v[112:115], a[100:103], a[36:39], v[112:115]
  v_exp_f32 v109, v109
  v_mfma_f32_16x16x32_bf16 v[112:115], a[104:107], a[40:43], v[112:115]
  ds_read_b64_tr_b16 a[142:143], v23 offset:36864
  v_cvt_pk_bf16_f32 v86, v108, v109
  v_mfma_f32_16x16x32_bf16 v[112:115], a[108:111], a[44:47], v[112:115]
  v_exp_f32 v110, v110
  v_mfma_f32_16x16x32_bf16 v[120:123], a[108:111], a[60:63], 0
  ds_read_b64_tr_b16 a[144:145], v24 offset:32768
  v_mul_f32 v111, s27, v111
  v_mfma_f32_16x16x32_bf16 v[120:123], a[104:107], a[56:59], v[120:123]
  v_exp_f32 v111, v111
  v_mfma_f32_16x16x32_bf16 v[120:123], a[100:103], a[52:55], v[120:123]
  v_mul_f32 v100, s27, v100
  v_cvt_pk_bf16_f32 v87, v110, v111
  v_mfma_f32_16x16x32_bf16 v[120:123], a[96:99], a[48:51], v[120:123]
  buffer_load_dwordx4 v29, s[12:15], s22 offen offset:1024 nt lds
  v_mfma_f32_16x16x32_bf16 v[124:127], a[112:115], a[48:51], 0
  s_add_u32 s49, s49, 8192
  v_exp_f32 v100, v100
  v_mul_f32 v101, s27, v101
  v_mfma_f32_16x16x32_bf16 v[124:127], a[116:119], a[52:55], v[124:127]
  s_and_b32 s49, s49, 0xffff
  ds_read_b64_tr_b16 a[146:147], v24 offset:36864
  v_mul_f32 v102, s27, v102
  v_mfma_f32_16x16x32_bf16 v[124:127], a[120:123], a[56:59], v[124:127]
  s_add_u32 s56, s56, 2048
  v_exp_f32 v101, v101
  v_mfma_f32_16x16x32_bf16 v[124:127], a[124:127], a[60:63], v[124:127]
  s_and_b32 s56, s56, 32767
  ds_read_b64_tr_b16 a[148:149], v25 offset:32768
  v_cvt_pk_bf16_f32 v82, v100, v101
  v_mfma_f32_16x16x32_bf16 v[116:119], a[124:127], a[44:47], 0
  s_add_u32 s22, s81, s56
  ds_read_b64_tr_b16 a[150:151], v25 offset:36864
  v_mul_f32 v103, s27, v103
  v_exp_f32 v102, v102
  v_mfma_f32_16x16x32_bf16 v[116:119], a[120:123], a[40:43], v[116:119]
  v_exp_f32 v103, v103
  v_mfma_f32_16x16x32_bf16 v[116:119], a[116:119], a[36:39], v[116:119]
  ds_read_b64_tr_b16 a[152:153], v26 offset:32768
  v_cvt_pk_bf16_f32 v83, v102, v103
  v_mfma_f32_16x16x32_bf16 v[116:119], a[112:115], a[32:35], v[116:119]
  s_waitcnt lgkmcnt(11)
  v_mul_f32 v112, s27, v112
  v_mul_f32 v113, s27, v113
  v_mfma_f32_16x16x32_bf16 v[128:131], a[128:131], v[80:83], v[128:131]
  s_add_u32 m0, s44, 4096
  v_exp_f32 v112, v112
  v_mfma_f32_16x16x32_bf16 v[160:163], a[128:131], v[84:87], v[160:163]
  s_waitcnt lgkmcnt(9)
  ds_read_b64_tr_b16 a[154:155], v26 offset:36864
  v_mul_f32 v114, s27, v114
  v_mfma_f32_16x16x32_bf16 v[132:135], a[132:135], v[80:83], v[132:135]
  buffer_load_dwordx4 v28, s[4:7], s70 offen offset:0 nt lds
  v_mfma_f32_16x16x32_bf16 v[164:167], a[132:135], v[84:87], v[164:167]
  s_waitcnt lgkmcnt(8)
  v_exp_f32 v113, v113
  v_mfma_f32_16x16x32_bf16 v[136:139], a[136:139], v[80:83], v[136:139]
  ds_read_b64_tr_b16 a[156:157], v27 offset:32768
  v_cvt_pk_bf16_f32 v88, v112, v113
  v_mfma_f32_16x16x32_bf16 v[168:171], a[136:139], v[84:87], v[168:171]
  v_exp_f32 v114, v114
  v_mfma_f32_16x16x32_bf16 a[224:227], a[240:243], v[80:83], a[224:227]
  s_waitcnt lgkmcnt(7)
  ds_read_b128 a[96:99], v16 offset:40960
  v_mul_f32 v115, s27, v115
  v_mfma_f32_16x16x32_bf16 v[140:143], a[140:143], v[80:83], v[140:143]
  ds_read_b64_tr_b16 a[158:159], v27 offset:36864
  v_exp_f32 v115, v115
  v_mfma_f32_16x16x32_bf16 v[172:175], a[140:143], v[84:87], v[172:175]
  s_waitcnt lgkmcnt(7)
  ds_read_b128 a[100:103], v17 offset:40960
  v_mul_f32 v120, s27, v120
  v_cvt_pk_bf16_f32 v89, v114, v115
  v_mfma_f32_16x16x32_bf16 v[144:147], a[144:147], v[80:83], v[144:147]
  v_exp_f32 v120, v120
  v_mfma_f32_16x16x32_bf16 v[176:179], a[144:147], v[84:87], v[176:179]
  s_waitcnt lgkmcnt(6)
  buffer_load_dwordx4 v29, s[4:7], s70 offen offset:1024 nt lds
  v_mfma_f32_16x16x32_bf16 v[148:151], a[148:151], v[80:83], v[148:151]
  ds_read_b128 a[104:107], v18 offset:40960
  ds_read_b128 a[108:111], v19 offset:40960
  v_mul_f32 v121, s27, v121
  v_mfma_f32_16x16x32_bf16 v[180:183], a[148:151], v[84:87], v[180:183]
  v_exp_f32 v121, v121
  v_mul_f32 v122, s27, v122
  v_mfma_f32_16x16x32_bf16 a[228:231], a[240:243], v[84:87], a[228:231]
  s_waitcnt lgkmcnt(6)
  v_cvt_pk_bf16_f32 v92, v120, v121
  v_mul_f32 v123, s27, v123
  v_exp_f32 v122, v122
  v_mfma_f32_16x16x32_bf16 v[152:155], a[152:155], v[80:83], v[152:155]
  v_exp_f32 v123, v123
  v_mfma_f32_16x16x32_bf16 v[184:187], a[152:155], v[84:87], v[184:187]
  s_waitcnt lgkmcnt(3)
  ds_read_b128 a[112:115], v16 offset:45056
  v_mul_f32 v124, s27, v124
  v_cvt_pk_bf16_f32 v93, v122, v123
  v_mfma_f32_16x16x32_bf16 v[156:159], a[156:159], v[80:83], v[156:159]
  v_exp_f32 v124, v124
  v_mul_f32 v125, s27, v125
  v_mfma_f32_16x16x32_bf16 v[188:191], a[156:159], v[84:87], v[188:191]
  ds_read_b128 a[116:119], v17 offset:45056
  v_exp_f32 v125, v125
  v_mfma_f32_16x16x32_bf16 v[96:99], a[96:99], a[0:3], 0
  s_waitcnt lgkmcnt(4)
  v_mul_f32 v126, s27, v126
  v_cvt_pk_bf16_f32 v94, v124, v125
  v_mfma_f32_16x16x32_bf16 v[96:99], a[100:103], a[4:7], v[96:99]
  s_waitcnt lgkmcnt(3)
  ds_read_b128 a[120:123], v18 offset:45056
  v_mul_f32 v127, s27, v127
  v_mfma_f32_16x16x32_bf16 v[96:99], a[104:107], a[8:11], v[96:99]
  s_waitcnt lgkmcnt(3)
  v_exp_f32 v126, v126
  v_mfma_f32_16x16x32_bf16 v[96:99], a[108:111], a[12:15], v[96:99]
  v_exp_f32 v127, v127
  v_mfma_f32_16x16x32_bf16 v[104:107], a[108:111], a[28:31], 0
  ds_read_b128 a[124:127], v19 offset:45056
  v_mul_f32 v116, s27, v116
  v_mfma_f32_16x16x32_bf16 v[104:107], a[104:107], a[24:27], v[104:107]
  v_cvt_pk_bf16_f32 v95, v126, v127
  v_mul_f32 v117, s27, v117
  v_mfma_f32_16x16x32_bf16 v[104:107], a[100:103], a[20:23], v[104:107]
  s_add_u32 m0, s29, 0
  v_exp_f32 v116, v116
  v_mfma_f32_16x16x32_bf16 v[104:107], a[96:99], a[16:19], v[104:107]
  s_waitcnt lgkmcnt(3)
  v_exp_f32 v117, v117
  v_mfma_f32_16x16x32_bf16 v[108:111], a[112:115], a[16:19], 0
  s_waitcnt lgkmcnt(2)
  v_mul_f32 v118, s27, v118
  v_cvt_pk_bf16_f32 v90, v116, v117
  v_mfma_f32_16x16x32_bf16 v[108:111], a[116:119], a[20:23], v[108:111]
  s_waitcnt lgkmcnt(1)
  buffer_load_dwordx4 v28, s[8:11], s21 offen offset:0 nt lds
  v_mfma_f32_16x16x32_bf16 v[108:111], a[120:123], a[24:27], v[108:111]
  s_waitcnt lgkmcnt(0)
  v_exp_f32 v118, v118
  v_mfma_f32_16x16x32_bf16 v[108:111], a[124:127], a[28:31], v[108:111]
  v_mul_f32 v119, s27, v119
  v_mul_f32 v96, s27, v96
  v_mfma_f32_16x16x32_bf16 v[100:103], a[124:127], a[12:15], 0
  v_exp_f32 v119, v119
  v_mfma_f32_16x16x32_bf16 v[100:103], a[120:123], a[8:11], v[100:103]
  v_cvt_pk_bf16_f32 v91, v118, v119
  v_mul_f32 v97, s27, v97
  v_mfma_f32_16x16x32_bf16 v[100:103], a[116:119], a[4:7], v[100:103]
  v_exp_f32 v96, v96
  v_mfma_f32_16x16x32_bf16 v[100:103], a[112:115], a[0:3], v[100:103]
  v_exp_f32 v97, v97
  v_mfma_f32_16x16x32_bf16 v[192:195], a[128:131], v[88:91], v[192:195]
  v_mul_f32 v98, s27, v98
  v_cvt_pk_bf16_f32 v80, v96, v97
  v_mfma_f32_16x16x32_bf16 v[224:227], a[128:131], v[92:95], v[224:227]
  buffer_load_dwordx4 v29, s[8:11], s21 offen offset:1024 nt lds
  v_mfma_f32_16x16x32_bf16 v[196:199], a[132:135], v[88:91], v[196:199]
  s_add_u32 s29, s29, 8192
  ds_read_b64_tr_b16 a[128:129], v20 offset:40960
  v_mul_f32 v99, s27, v99
  v_mfma_f32_16x16x32_bf16 v[228:231], a[132:135], v[92:95], v[228:231]
  s_and_b32 s29, s29, 0xffff
  v_exp_f32 v98, v98
  v_mfma_f32_16x16x32_bf16 v[200:203], a[136:139], v[88:91], v[200:203]
  s_add_u32 s55, s55, 2048
  ds_read_b64_tr_b16 a[130:131], v20 offset:45056
  v_mul_f32 v104, s27, v104
  v_mfma_f32_16x16x32_bf16 v[232:235], a[136:139], v[92:95], v[232:235]
  s_and_b32 s55, s55, 32767
  v_exp_f32 v99, v99
  v_mfma_f32_16x16x32_bf16 a[232:235], a[240:243], v[88:91], a[232:235]
  s_add_u32 s21, s80, s55
  ds_read_b64_tr_b16 a[132:133], v21 offset:40960
  v_cvt_pk_bf16_f32 v81, v98, v99
  v_mfma_f32_16x16x32_bf16 v[204:207], a[140:143], v[88:91], v[204:207]
  v_exp_f32 v104, v104
  v_mfma_f32_16x16x32_bf16 v[236:239], a[140:143], v[92:95], v[236:239]
  s_add_u32 m0, s49, 65536
  ds_read_b64_tr_b16 a[134:135], v21 offset:45056
  v_mul_f32 v105, s27, v105
  v_mfma_f32_16x16x32_bf16 v[208:211], a[144:147], v[88:91], v[208:211]
  buffer_load_dwordx4 v28, s[12:15], s22 offen offset:0 nt lds
  v_mfma_f32_16x16x32_bf16 v[240:243], a[144:147], v[92:95], v[240:243]
  v_exp_f32 v105, v105
  v_mfma_f32_16x16x32_bf16 v[212:215], a[148:151], v[88:91], v[212:215]
  v_mul_f32 v106, s27, v106
  v_cvt_pk_bf16_f32 v84, v104, v105
  v_mfma_f32_16x16x32_bf16 v[244:247], a[148:151], v[92:95], v[244:247]
  v_exp_f32 v106, v106
  v_mfma_f32_16x16x32_bf16 a[236:239], a[240:243], v[92:95], a[236:239]
  ds_read_b64_tr_b16 a[136:137], v22 offset:40960
  v_mul_f32 v107, s27, v107
  v_mfma_f32_16x16x32_bf16 v[216:219], a[152:155], v[88:91], v[216:219]
  v_exp_f32 v107, v107
  v_mfma_f32_16x16x32_bf16 v[248:251], a[152:155], v[92:95], v[248:251]
  v_mul_f32 v108, s27, v108
  v_cvt_pk_bf16_f32 v85, v106, v107
  v_mfma_f32_16x16x32_bf16 v[220:223], a[156:159], v[88:91], v[220:223]
  ds_read_b64_tr_b16 a[138:139], v22 offset:45056
  v_mul_f32 v109, s27, v109
  v_mfma_f32_16x16x32_bf16 v[252:255], a[156:159], v[92:95], v[252:255]
  buffer_load_dwordx4 v29, s[12:15], s22 offen offset:1024 nt lds
  v_mfma_f32_16x16x32_bf16 v[112:115], a[96:99], a[32:35], 0
  s_add_u32 s49, s49, 8192
  v_exp_f32 v108, v108
  v_mfma_f32_16x16x32_bf16 v[112:115], a[100:103], a[36:39], v[112:115]
  s_and_b32 s49, s49, 0xffff
  ds_read_b64_tr_b16 a[140:141], v23 offset:40960
  v_mul_f32 v110, s27, v110
  v_mfma_f32_16x16x32_bf16 v[112:115], a[104:107], a[40:43], v[112:115]
  s_add_u32 s56, s56, 2048
  v_exp_f32 v109, v109
  v_mfma_f32_16x16x32_bf16 v[112:115], a[108:111], a[44:47], v[112:115]
  s_and_b32 s56, s56, 32767
  ds_read_b64_tr_b16 a[142:143], v23 offset:45056
  v_cvt_pk_bf16_f32 v86, v108, v109
  v_mfma_f32_16x16x32_bf16 v[120:123], a[108:111], a[60:63], 0
  s_add_u32 s22, s81, s56
  v_exp_f32 v110, v110
  v_mul_f32 v111, s27, v111
  v_mfma_f32_16x16x32_bf16 v[120:123], a[104:107], a[56:59], v[120:123]
  v_exp_f32 v111, v111
  v_mfma_f32_16x16x32_bf16 v[120:123], a[100:103], a[52:55], v[120:123]
  ds_read_b64_tr_b16 a[144:145], v24 offset:40960
  v_mul_f32 v100, s27, v100
  v_cvt_pk_bf16_f32 v87, v110, v111
  v_mfma_f32_16x16x32_bf16 v[120:123], a[96:99], a[48:51], v[120:123]
  v_exp_f32 v100, v100
  v_mfma_f32_16x16x32_bf16 v[124:127], a[112:115], a[48:51], 0
  ds_read_b64_tr_b16 a[146:147], v24 offset:45056
  v_mul_f32 v101, s27, v101
  v_mfma_f32_16x16x32_bf16 v[124:127], a[116:119], a[52:55], v[124:127]
  v_exp_f32 v101, v101
  v_mfma_f32_16x16x32_bf16 v[124:127], a[120:123], a[56:59], v[124:127]
  v_mul_f32 v102, s27, v102
  v_cvt_pk_bf16_f32 v82, v100, v101
  v_mfma_f32_16x16x32_bf16 v[124:127], a[124:127], a[60:63], v[124:127]
  ds_read_b64_tr_b16 a[148:149], v25 offset:40960
  v_mul_f32 v103, s27, v103
  v_mfma_f32_16x16x32_bf16 v[116:119], a[124:127], a[44:47], 0
  v_exp_f32 v102, v102
  v_mfma_f32_16x16x32_bf16 v[116:119], a[120:123], a[40:43], v[116:119]
  ds_read_b64_tr_b16 a[150:151], v25 offset:45056
  v_exp_f32 v103, v103
  v_mfma_f32_16x16x32_bf16 v[116:119], a[116:119], a[36:39], v[116:119]
  ds_read_b64_tr_b16 a[152:153], v26 offset:40960
  v_cvt_pk_bf16_f32 v83, v102, v103
  v_mfma_f32_16x16x32_bf16 v[116:119], a[112:115], a[32:35], v[116:119]
  s_waitcnt lgkmcnt(11)
  v_mul_f32 v112, s27, v112
  v_mul_f32 v113, s27, v113
  v_mfma_f32_16x16x32_bf16 v[128:131], a[128:131], v[80:83], v[128:131]
  s_add_u32 m0, s44, 6144
  v_exp_f32 v112, v112
  v_mfma_f32_16x16x32_bf16 v[160:163], a[128:131], v[84:87], v[160:163]
  s_waitcnt lgkmcnt(9)
  ds_read_b64_tr_b16 a[154:155], v26 offset:45056
  v_mul_f32 v114, s27, v114
  v_mfma_f32_16x16x32_bf16 v[132:135], a[132:135], v[80:83], v[132:135]
  buffer_load_dwordx4 v28, s[4:7], s71 offen offset:0 nt lds
  v_mfma_f32_16x16x32_bf16 v[164:167], a[132:135], v[84:87], v[164:167]
  s_waitcnt lgkmcnt(8)
  v_exp_f32 v113, v113
  v_mfma_f32_16x16x32_bf16 v[136:139], a[136:139], v[80:83], v[136:139]
  ds_read_b64_tr_b16 a[156:157], v27 offset:40960
  v_cvt_pk_bf16_f32 v88, v112, v113
  v_mfma_f32_16x16x32_bf16 v[168:171], a[136:139], v[84:87], v[168:171]
  v_exp_f32 v114, v114
  v_mfma_f32_16x16x32_bf16 a[224:227], a[240:243], v[80:83], a[224:227]
  s_waitcnt lgkmcnt(7)
  ds_read_b128 a[96:99], v16 offset:49152
  v_mul_f32 v115, s27, v115
  v_mfma_f32_16x16x32_bf16 v[140:143], a[140:143], v[80:83], v[140:143]
  ds_read_b64_tr_b16 a[158:159], v27 offset:45056
  v_exp_f32 v115, v115
  v_mfma_f32_16x16x32_bf16 v[172:175], a[140:143], v[84:87], v[172:175]
  s_waitcnt lgkmcnt(7)
  ds_read_b128 a[100:103], v17 offset:49152
  v_mul_f32 v120, s27, v120
  v_cvt_pk_bf16_f32 v89, v114, v115
  v_mfma_f32_16x16x32_bf16 v[144:147], a[144:147], v[80:83], v[144:147]
  v_exp_f32 v120, v120
  v_mfma_f32_16x16x32_bf16 v[176:179], a[144:147], v[84:87], v[176:179]
  s_waitcnt lgkmcnt(6)
  buffer_load_dwordx4 v29, s[4:7], s71 offen offset:1024 nt lds
  v_mfma_f32_16x16x32_bf16 v[148:151], a[148:151], v[80:83], v[148:151]
  ds_read_b128 a[104:107], v18 offset:49152
  ds_read_b128 a[108:111], v19 offset:49152
  v_mul_f32 v121, s27, v121
  v_mfma_f32_16x16x32_bf16 v[180:183], a[148:151], v[84:87], v[180:183]
  v_exp_f32 v121, v121
  v_mul_f32 v122, s27, v122
  v_mfma_f32_16x16x32_bf16 a[228:231], a[240:243], v[84:87], a[228:231]
  s_waitcnt lgkmcnt(6)
  v_cvt_pk_bf16_f32 v92, v120, v121
  v_mul_f32 v123, s27, v123
  v_exp_f32 v122, v122
  v_mfma_f32_16x16x32_bf16 v[152:155], a[152:155], v[80:83], v[152:155]
  v_exp_f32 v123, v123
  v_mfma_f32_16x16x32_bf16 v[184:187], a[152:155], v[84:87], v[184:187]
  s_waitcnt lgkmcnt(3)
  ds_read_b128 a[112:115], v16 offset:53248
  v_mul_f32 v124, s27, v124
  v_cvt_pk_bf16_f32 v93, v122, v123
  v_mfma_f32_16x16x32_bf16 v[156:159], a[156:159], v[80:83], v[156:159]
  v_exp_f32 v124, v124
  v_mul_f32 v125, s27, v125
  v_mfma_f32_16x16x32_bf16 v[188:191], a[156:159], v[84:87], v[188:191]
  ds_read_b128 a[116:119], v17 offset:53248
  v_exp_f32 v125, v125
  v_mfma_f32_16x16x32_bf16 v[96:99], a[96:99], a[0:3], 0
  s_waitcnt lgkmcnt(4)
  v_mul_f32 v126, s27, v126
  v_cvt_pk_bf16_f32 v94, v124, v125
  v_mfma_f32_16x16x32_bf16 v[96:99], a[100:103], a[4:7], v[96:99]
  s_waitcnt lgkmcnt(3)
  ds_read_b128 a[120:123], v18 offset:53248
  v_mul_f32 v127, s27, v127
  v_mfma_f32_16x16x32_bf16 v[96:99], a[104:107], a[8:11], v[96:99]
  s_waitcnt lgkmcnt(3)
  v_exp_f32 v126, v126
  v_mfma_f32_16x16x32_bf16 v[96:99], a[108:111], a[12:15], v[96:99]
  v_exp_f32 v127, v127
  v_mfma_f32_16x16x32_bf16 v[104:107], a[108:111], a[28:31], 0
  ds_read_b128 a[124:127], v19 offset:53248
  v_mul_f32 v116, s27, v116
  v_mfma_f32_16x16x32_bf16 v[104:107], a[104:107], a[24:27], v[104:107]
  v_cvt_pk_bf16_f32 v95, v126, v127
  v_mul_f32 v117, s27, v117
  v_mfma_f32_16x16x32_bf16 v[104:107], a[100:103], a[20:23], v[104:107]
  v_exp_f32 v116, v116
  v_mfma_f32_16x16x32_bf16 v[104:107], a[96:99], a[16:19], v[104:107]
  s_waitcnt lgkmcnt(3)
  v_exp_f32 v117, v117
  v_mfma_f32_16x16x32_bf16 v[108:111], a[112:115], a[16:19], 0
  s_waitcnt lgkmcnt(2)
  v_mul_f32 v118, s27, v118
  v_cvt_pk_bf16_f32 v90, v116, v117
  v_mfma_f32_16x16x32_bf16 v[108:111], a[116:119], a[20:23], v[108:111]
  s_waitcnt lgkmcnt(1)
  v_exp_f32 v118, v118
  v_mfma_f32_16x16x32_bf16 v[108:111], a[120:123], a[24:27], v[108:111]
  s_waitcnt lgkmcnt(0)
  v_mul_f32 v119, s27, v119
  v_mul_f32 v96, s27, v96
  v_mfma_f32_16x16x32_bf16 v[108:111], a[124:127], a[28:31], v[108:111]
  v_exp_f32 v119, v119
  v_mfma_f32_16x16x32_bf16 v[100:103], a[124:127], a[12:15], 0
  v_cvt_pk_bf16_f32 v91, v118, v119
  v_mul_f32 v97, s27, v97
  v_mfma_f32_16x16x32_bf16 v[100:103], a[120:123], a[8:11], v[100:103]
  s_waitcnt vmcnt(12)
  v_exp_f32 v96, v96
  v_mfma_f32_16x16x32_bf16 v[100:103], a[116:119], a[4:7], v[100:103]
  s_barrier
  v_exp_f32 v97, v97
  v_mfma_f32_16x16x32_bf16 v[100:103], a[112:115], a[0:3], v[100:103]
  v_mul_f32 v98, s27, v98
  v_cvt_pk_bf16_f32 v80, v96, v97
  v_mfma_f32_16x16x32_bf16 v[192:195], a[128:131], v[88:91], v[192:195]
  s_add_u32 m0, s29, 0
  v_exp_f32 v98, v98
  v_mfma_f32_16x16x32_bf16 v[224:227], a[128:131], v[92:95], v[224:227]
  buffer_load_dwordx4 v28, s[8:11], s21 offen offset:0 nt lds
  v_mfma_f32_16x16x32_bf16 v[196:199], a[132:135], v[88:91], v[196:199]
  ds_read_b64_tr_b16 a[128:129], v20 offset:49152
  v_mul_f32 v99, s27, v99
  v_mfma_f32_16x16x32_bf16 v[228:231], a[132:135], v[92:95], v[228:231]
  ds_read_b64_tr_b16 a[130:131], v20 offset:53248
  v_mul_f32 v104, s27, v104
  v_mfma_f32_16x16x32_bf16 v[200:203], a[136:139], v[88:91], v[200:203]
  v_exp_f32 v99, v99
  v_mfma_f32_16x16x32_bf16 v[232:235], a[136:139], v[92:95], v[232:235]
  ds_read_b64_tr_b16 a[132:133], v21 offset:49152
  v_cvt_pk_bf16_f32 v81, v98, v99
  v_mfma_f32_16x16x32_bf16 a[232:235], a[240:243], v[88:91], a[232:235]
  v_exp_f32 v104, v104
  v_mfma_f32_16x16x32_bf16 v[204:207], a[140:143], v[88:91], v[204:207]
  ds_read_b64_tr_b16 a[134:135], v21 offset:53248
  v_mul_f32 v105, s27, v105
  v_mfma_f32_16x16x32_bf16 v[236:239], a[140:143], v[92:95], v[236:239]
  v_exp_f32 v105, v105
  v_mfma_f32_16x16x32_bf16 v[208:211], a[144:147], v[88:91], v[208:211]
  buffer_load_dwordx4 v29, s[8:11], s21 offen offset:1024 nt lds
  v_mfma_f32_16x16x32_bf16 v[240:243], a[144:147], v[92:95], v[240:243]
  s_add_u32 s29, s29, 8192
  v_mul_f32 v106, s27, v106
  v_cvt_pk_bf16_f32 v84, v104, v105
  v_mfma_f32_16x16x32_bf16 v[212:215], a[148:151], v[88:91], v[212:215]
  s_and_b32 s29, s29, 0xffff
  v_exp_f32 v106, v106
  v_mfma_f32_16x16x32_bf16 v[244:247], a[148:151], v[92:95], v[244:247]
  s_add_u32 s55, s55, 2048
  ds_read_b64_tr_b16 a[136:137], v22 offset:49152
  v_mul_f32 v107, s27, v107
  v_mfma_f32_16x16x32_bf16 a[236:239], a[240:243], v[92:95], a[236:239]
  s_and_b32 s55, s55, 32767
  v_exp_f32 v107, v107
  v_mfma_f32_16x16x32_bf16 v[216:219], a[152:155], v[88:91], v[216:219]
  s_add_u32 s21, s80, s55
  v_mul_f32 v108, s27, v108
  v_cvt_pk_bf16_f32 v85, v106, v107
  v_mfma_f32_16x16x32_bf16 v[248:251], a[152:155], v[92:95], v[248:251]
  ds_read_b64_tr_b16 a[138:139], v22 offset:53248
  v_mul_f32 v109, s27, v109
  v_mfma_f32_16x16x32_bf16 v[220:223], a[156:159], v[88:91], v[220:223]
  s_add_u32 m0, s49, 65536
  v_exp_f32 v108, v108
  v_mfma_f32_16x16x32_bf16 v[252:255], a[156:159], v[92:95], v[252:255]
  buffer_load_dwordx4 v28, s[12:15], s22 offen offset:0 nt lds
  v_mfma_f32_16x16x32_bf16 v[112:115], a[96:99], a[32:35], 0
  ds_read_b64_tr_b16 a[140:141], v23 offset:49152
  v_mul_f32 v110, s27, v110
  v_mfma_f32_16x16x32_bf16 v[112:115], a[100:103], a[36:39], v[112:115]
  v_exp_f32 v109, v109
  v_mfma_f32_16x16x32_bf16 v[112:115], a[104:107], a[40:43], v[112:115]
  ds_read_b64_tr_b16 a[142:143], v23 offset:53248
  v_cvt_pk_bf16_f32 v86, v108, v109
  v_mfma_f32_16x16x32_bf16 v[112:115], a[108:111], a[44:47], v[112:115]
  v_exp_f32 v110, v110
  v_mfma_f32_16x16x32_bf16 v[120:123], a[108:111], a[60:63], 0
  ds_read_b64_tr_b16 a[144:145], v24 offset:49152
  v_mul_f32 v111, s27, v111
  v_mfma_f32_16x16x32_bf16 v[120:123], a[104:107], a[56:59], v[120:123]
  v_exp_f32 v111, v111
  v_mfma_f32_16x16x32_bf16 v[120:123], a[100:103], a[52:55], v[120:123]
  v_mul_f32 v100, s27, v100
  v_cvt_pk_bf16_f32 v87, v110, v111
  v_mfma_f32_16x16x32_bf16 v[120:123], a[96:99], a[48:51], v[120:123]
  buffer_load_dwordx4 v29, s[12:15], s22 offen offset:1024 nt lds
  v_mfma_f32_16x16x32_bf16 v[124:127], a[112:115], a[48:51], 0
  s_add_u32 s49, s49, 8192
  v_exp_f32 v100, v100
  v_mul_f32 v101, s27, v101
  v_mfma_f32_16x16x32_bf16 v[124:127], a[116:119], a[52:55], v[124:127]
  s_and_b32 s49, s49, 0xffff
  ds_read_b64_tr_b16 a[146:147], v24 offset:53248
  v_mul_f32 v102, s27, v102
  v_mfma_f32_16x16x32_bf16 v[124:127], a[120:123], a[56:59], v[124:127]
  s_add_u32 s56, s56, 2048
  v_exp_f32 v101, v101
  v_mfma_f32_16x16x32_bf16 v[124:127], a[124:127], a[60:63], v[124:127]
  s_and_b32 s56, s56, 32767
  ds_read_b64_tr_b16 a[148:149], v25 offset:49152
  v_cvt_pk_bf16_f32 v82, v100, v101
  v_mfma_f32_16x16x32_bf16 v[116:119], a[124:127], a[44:47], 0
  s_add_u32 s22, s81, s56
  ds_read_b64_tr_b16 a[150:151], v25 offset:53248
  v_mul_f32 v103, s27, v103
  v_exp_f32 v102, v102
  v_mfma_f32_16x16x32_bf16 v[116:119], a[120:123], a[40:43], v[116:119]
  v_exp_f32 v103, v103
  v_mfma_f32_16x16x32_bf16 v[116:119], a[116:119], a[36:39], v[116:119]
  ds_read_b64_tr_b16 a[152:153], v26 offset:49152
  v_cvt_pk_bf16_f32 v83, v102, v103
  v_mfma_f32_16x16x32_bf16 v[116:119], a[112:115], a[32:35], v[116:119]
  s_waitcnt lgkmcnt(11)
  v_mul_f32 v112, s27, v112
  v_mul_f32 v113, s27, v113
  v_mfma_f32_16x16x32_bf16 v[128:131], a[128:131], v[80:83], v[128:131]
  v_exp_f32 v112, v112
  v_mfma_f32_16x16x32_bf16 v[160:163], a[128:131], v[84:87], v[160:163]
  s_waitcnt lgkmcnt(9)
  ds_read_b64_tr_b16 a[154:155], v26 offset:53248
  v_mul_f32 v114, s27, v114
  v_mfma_f32_16x16x32_bf16 v[132:135], a[132:135], v[80:83], v[132:135]
  buffer_store_dwordx4 a[168:171], v40, s[16:19], s73 offen offset:0 nt
  ds_read_b64_tr_b16 a[156:157], v27 offset:49152
  v_exp_f32 v113, v113
  v_mfma_f32_16x16x32_bf16 v[164:167], a[132:135], v[84:87], v[164:167]
  s_waitcnt lgkmcnt(9)
  ds_read_b128 a[96:99], v16 offset:57344
  v_cvt_pk_bf16_f32 v88, v112, v113
  v_mfma_f32_16x16x32_bf16 v[136:139], a[136:139], v[80:83], v[136:139]
  v_exp_f32 v114, v114
  v_mfma_f32_16x16x32_bf16 v[168:171], a[136:139], v[84:87], v[168:171]
  ds_read_b64_tr_b16 a[158:159], v27 offset:53248
  v_mul_f32 v115, s27, v115
  v_mfma_f32_16x16x32_bf16 a[224:227], a[240:243], v[80:83], a[224:227]
  s_waitcnt lgkmcnt(9)
  v_exp_f32 v115, v115
  v_mfma_f32_16x16x32_bf16 v[140:143], a[140:143], v[80:83], v[140:143]
  v_mul_f32 v120, s27, v120
  v_cvt_pk_bf16_f32 v89, v114, v115
  v_mfma_f32_16x16x32_bf16 v[172:175], a[140:143], v[84:87], v[172:175]
  s_waitcnt lgkmcnt(7)
  ds_read_b128 a[100:103], v17 offset:57344
  v_mul_f32 v121, s27, v121
  v_mfma_f32_16x16x32_bf16 v[144:147], a[144:147], v[80:83], v[144:147]
  v_exp_f32 v120, v120
  v_mfma_f32_16x16x32_bf16 v[176:179], a[144:147], v[84:87], v[176:179]
  s_waitcnt lgkmcnt(6)
  buffer_store_dwordx4 a[172:175], v40, s[16:19], s73 offen offset:1024 nt
  ds_read_b128 a[104:107], v18 offset:57344
  v_exp_f32 v121, v121
  v_mfma_f32_16x16x32_bf16 v[148:151], a[148:151], v[80:83], v[148:151]
  v_mul_f32 v122, s27, v122
  v_cvt_pk_bf16_f32 v92, v120, v121
  v_mfma_f32_16x16x32_bf16 v[180:183], a[148:151], v[84:87], v[180:183]
  v_exp_f32 v122, v122
  v_mfma_f32_16x16x32_bf16 a[228:231], a[240:243], v[84:87], a[228:231]
  s_waitcnt lgkmcnt(5)
  ds_read_b128 a[108:111], v19 offset:57344
  v_mul_f32 v123, s27, v123
  v_mfma_f32_16x16x32_bf16 v[152:155], a[152:155], v[80:83], v[152:155]
  v_exp_f32 v123, v123
  v_mfma_f32_16x16x32_bf16 v[184:187], a[152:155], v[84:87], v[184:187]
  s_waitcnt lgkmcnt(3)
  ds_read_b128 a[112:115], v16 offset:61440
  v_mul_f32 v124, s27, v124
  v_cvt_pk_bf16_f32 v93, v122, v123
  v_mfma_f32_16x16x32_bf16 v[156:159], a[156:159], v[80:83], v[156:159]
  v_exp_f32 v124, v124
  v_mul_f32 v125, s27, v125
  v_mfma_f32_16x16x32_bf16 v[188:191], a[156:159], v[84:87], v[188:191]
  ds_read_b128 a[116:119], v17 offset:61440
  v_exp_f32 v125, v125
  v_mfma_f32_16x16x32_bf16 v[96:99], a[96:99], a[0:3], 0
  s_waitcnt lgkmcnt(4)
  v_mul_f32 v126, s27, v126
  v_cvt_pk_bf16_f32 v94, v124, v125
  v_mfma_f32_16x16x32_bf16 v[96:99], a[100:103], a[4:7], v[96:99]
  s_waitcnt lgkmcnt(3)
  ds_read_b128 a[120:123], v18 offset:61440
  v_mul_f32 v127, s27, v127
  v_mfma_f32_16x16x32_bf16 v[96:99], a[104:107], a[8:11], v[96:99]
  s_waitcnt lgkmcnt(3)
  v_exp_f32 v126, v126
  v_mfma_f32_16x16x32_bf16 v[96:99], a[108:111], a[12:15], v[96:99]
  v_exp_f32 v127, v127
  v_mfma_f32_16x16x32_bf16 v[104:107], a[108:111], a[28:31], 0
  ds_read_b128 a[124:127], v19 offset:61440
  v_mul_f32 v116, s27, v116
  v_mfma_f32_16x16x32_bf16 v[104:107], a[104:107], a[24:27], v[104:107]
  v_cvt_pk_bf16_f32 v95, v126, v127
  v_mul_f32 v117, s27, v117
  v_mfma_f32_16x16x32_bf16 v[104:107], a[100:103], a[20:23], v[104:107]
  s_add_u32 m0, s29, 0
  v_exp_f32 v116, v116
  v_mfma_f32_16x16x32_bf16 v[104:107], a[96:99], a[16:19], v[104:107]
  s_waitcnt lgkmcnt(3)
  v_exp_f32 v117, v117
  v_mfma_f32_16x16x32_bf16 v[108:111], a[112:115], a[16:19], 0
  s_waitcnt lgkmcnt(2)
  v_mul_f32 v118, s27, v118
  v_cvt_pk_bf16_f32 v90, v116, v117
  v_mfma_f32_16x16x32_bf16 v[108:111], a[116:119], a[20:23], v[108:111]
  s_waitcnt lgkmcnt(1)
  buffer_load_dwordx4 v28, s[8:11], s21 offen offset:0 nt lds
  v_mfma_f32_16x16x32_bf16 v[108:111], a[120:123], a[24:27], v[108:111]
  s_waitcnt lgkmcnt(0)
  v_exp_f32 v118, v118
  v_mfma_f32_16x16x32_bf16 v[108:111], a[124:127], a[28:31], v[108:111]
  v_mul_f32 v119, s27, v119
  v_mul_f32 v96, s27, v96
  v_mfma_f32_16x16x32_bf16 v[100:103], a[124:127], a[12:15], 0
  v_exp_f32 v119, v119
  v_mfma_f32_16x16x32_bf16 v[100:103], a[120:123], a[8:11], v[100:103]
  v_cvt_pk_bf16_f32 v91, v118, v119
  v_mul_f32 v97, s27, v97
  v_mfma_f32_16x16x32_bf16 v[100:103], a[116:119], a[4:7], v[100:103]
  v_exp_f32 v96, v96
  v_mfma_f32_16x16x32_bf16 v[100:103], a[112:115], a[0:3], v[100:103]
  v_exp_f32 v97, v97
  v_mfma_f32_16x16x32_bf16 v[192:195], a[128:131], v[88:91], v[192:195]
  v_mul_f32 v98, s27, v98
  v_cvt_pk_bf16_f32 v80, v96, v97
  v_mfma_f32_16x16x32_bf16 v[224:227], a[128:131], v[92:95], v[224:227]
  buffer_load_dwordx4 v29, s[8:11], s21 offen offset:1024 nt lds
  v_mfma_f32_16x16x32_bf16 v[196:199], a[132:135], v[88:91], v[196:199]
  s_add_u32 s29, s29, 8192
  ds_read_b64_tr_b16 a[128:129], v20 offset:57344
  v_mul_f32 v99, s27, v99
  v_mfma_f32_16x16x32_bf16 v[228:231], a[132:135], v[92:95], v[228:231]
  s_and_b32 s29, s29, 0xffff
  v_exp_f32 v98, v98
  v_mfma_f32_16x16x32_bf16 v[200:203], a[136:139], v[88:91], v[200:203]
  s_add_u32 s55, s55, 2048
  ds_read_b64_tr_b16 a[130:131], v20 offset:61440
  v_mul_f32 v104, s27, v104
  v_mfma_f32_16x16x32_bf16 v[232:235], a[136:139], v[92:95], v[232:235]
  s_and_b32 s55, s55, 32767
  v_exp_f32 v99, v99
  v_mfma_f32_16x16x32_bf16 a[232:235], a[240:243], v[88:91], a[232:235]
  s_add_u32 s21, s80, s55
  ds_read_b64_tr_b16 a[132:133], v21 offset:57344
  v_cvt_pk_bf16_f32 v81, v98, v99
  v_mfma_f32_16x16x32_bf16 v[204:207], a[140:143], v[88:91], v[204:207]
  v_exp_f32 v104, v104
  v_mfma_f32_16x16x32_bf16 v[236:239], a[140:143], v[92:95], v[236:239]
  s_add_u32 m0, s49, 65536
  ds_read_b64_tr_b16 a[134:135], v21 offset:61440
  v_mul_f32 v105, s27, v105
  v_mfma_f32_16x16x32_bf16 v[208:211], a[144:147], v[88:91], v[208:211]
  buffer_load_dwordx4 v28, s[12:15], s22 offen offset:0 nt lds
  v_mfma_f32_16x16x32_bf16 v[240:243], a[144:147], v[92:95], v[240:243]
  v_exp_f32 v105, v105
  v_mfma_f32_16x16x32_bf16 v[212:215], a[148:151], v[88:91], v[212:215]
  v_mul_f32 v106, s27, v106
  v_cvt_pk_bf16_f32 v84, v104, v105
  v_mfma_f32_16x16x32_bf16 v[244:247], a[148:151], v[92:95], v[244:247]
  v_exp_f32 v106, v106
  v_mfma_f32_16x16x32_bf16 a[236:239], a[240:243], v[92:95], a[236:239]
  s_waitcnt vmcnt(9)
  ds_read_b64_tr_b16 a[136:137], v22 offset:57344
  v_mul_f32 v107, s27, v107
  v_mfma_f32_16x16x32_bf16 v[216:219], a[152:155], v[88:91], v[216:219]
  v_exp_f32 v107, v107
  v_mfma_f32_16x16x32_bf16 v[248:251], a[152:155], v[92:95], v[248:251]
  v_mul_f32 v108, s27, v108
  v_cvt_pk_bf16_f32 v85, v106, v107
  v_mfma_f32_16x16x32_bf16 v[220:223], a[156:159], v[88:91], v[220:223]
  ds_read_b128 a[64:67], v30 offset:0
  ds_read_b64_tr_b16 a[138:139], v22 offset:61440
  v_mfma_f32_16x16x32_bf16 v[252:255], a[156:159], v[92:95], v[252:255]
  buffer_load_dwordx4 v29, s[12:15], s22 offen offset:1024 nt lds
  v_mfma_f32_16x16x32_bf16 v[112:115], a[96:99], a[32:35], 0
  s_add_u32 s49, s49, 8192
  v_exp_f32 v108, v108
  v_mul_f32 v109, s27, v109
  v_mfma_f32_16x16x32_bf16 v[112:115], a[100:103], a[36:39], v[112:115]
  s_and_b32 s49, s49, 0xffff
  ds_read_b64_tr_b16 a[140:141], v23 offset:57344
  v_mul_f32 v110, s27, v110
  v_mfma_f32_16x16x32_bf16 v[112:115], a[104:107], a[40:43], v[112:115]
  s_add_u32 s56, s56, 2048
  ds_read_b128 a[68:71], v31 offset:0
  v_exp_f32 v109, v109
  v_mfma_f32_16x16x32_bf16 v[112:115], a[108:111], a[44:47], v[112:115]
  s_and_b32 s56, s56, 32767
  ds_read_b64_tr_b16 a[142:143], v23 offset:61440
  v_cvt_pk_bf16_f32 v86, v108, v109
  v_mfma_f32_16x16x32_bf16 v[120:123], a[108:111], a[60:63], 0
  s_add_u32 s22, s81, s56
  v_exp_f32 v110, v110
  v_mul_f32 v111, s27, v111
  v_mfma_f32_16x16x32_bf16 v[120:123], a[104:107], a[56:59], v[120:123]
  v_exp_f32 v111, v111
  v_mfma_f32_16x16x32_bf16 v[120:123], a[100:103], a[52:55], v[120:123]
  ds_read_b64_tr_b16 a[144:145], v24 offset:57344
  v_mul_f32 v100, s27, v100
  v_cvt_pk_bf16_f32 v87, v110, v111
  v_mfma_f32_16x16x32_bf16 v[120:123], a[96:99], a[48:51], v[120:123]
  ds_read_b128 a[72:75], v32 offset:0
  v_mul_f32 v101, s27, v101
  v_mfma_f32_16x16x32_bf16 v[124:127], a[112:115], a[48:51], 0
  ds_read_b64_tr_b16 a[146:147], v24 offset:61440
  v_exp_f32 v100, v100
  v_mfma_f32_16x16x32_bf16 v[124:127], a[116:119], a[52:55], v[124:127]
  v_exp_f32 v101, v101
  v_mfma_f32_16x16x32_bf16 v[124:127], a[120:123], a[56:59], v[124:127]
  ds_read_b128 a[76:79], v33 offset:0
  v_mul_f32 v102, s27, v102
  v_cvt_pk_bf16_f32 v82, v100, v101
  v_mfma_f32_16x16x32_bf16 v[124:127], a[124:127], a[60:63], v[124:127]
  ds_read_b64_tr_b16 a[148:149], v25 offset:57344
  v_mul_f32 v103, s27, v103
  v_mfma_f32_16x16x32_bf16 v[116:119], a[124:127], a[44:47], 0
  v_exp_f32 v102, v102
  v_mfma_f32_16x16x32_bf16 v[116:119], a[120:123], a[40:43], v[116:119]
  ds_read_b64_tr_b16 a[150:151], v25 offset:61440
  v_exp_f32 v103, v103
  v_mfma_f32_16x16x32_bf16 v[116:119], a[116:119], a[36:39], v[116:119]
  ds_read_b128 a[80:83], v30 offset:4096
  v_cvt_pk_bf16_f32 v83, v102, v103
  v_mfma_f32_16x16x32_bf16 v[116:119], a[112:115], a[32:35], v[116:119]
  s_waitcnt lgkmcnt(15)
  ds_read_b64_tr_b16 a[152:153], v26 offset:57344
  v_mul_f32 v112, s27, v112
  v_mfma_f32_16x16x32_bf16 v[128:131], a[128:131], v[80:83], v[128:131]
  v_exp_f32 v112, v112
  v_mfma_f32_16x16x32_bf16 v[160:163], a[128:131], v[84:87], v[160:163]
  s_waitcnt lgkmcnt(14)
  ds_read_b128 a[84:87], v31 offset:4096
  v_mul_f32 v113, s27, v113
  v_mfma_f32_16x16x32_bf16 v[132:135], a[132:135], v[80:83], v[132:135]
  buffer_store_dwordx4 a[176:179], v40, s[16:19], s74 offen offset:0 nt
  ds_read_b64_tr_b16 a[154:155], v26 offset:61440
  v_exp_f32 v113, v113
  v_mfma_f32_16x16x32_bf16 v[164:167], a[132:135], v[84:87], v[164:167]
  s_waitcnt lgkmcnt(13)
  v_mul_f32 v114, s27, v114
  v_cvt_pk_bf16_f32 v88, v112, v113
  v_mfma_f32_16x16x32_bf16 v[136:139], a[136:139], v[80:83], v[136:139]
  ds_read_b64_tr_b16 a[156:157], v27 offset:57344
  ds_read_b128 a[96:99], v16 offset:0
  v_mfma_f32_16x16x32_bf16 v[168:171], a[136:139], v[84:87], v[168:171]
  v_exp_f32 v114, v114
  v_mfma_f32_16x16x32_bf16 a[224:227], a[240:243], v[80:83], a[224:227]
  s_waitcnt lgkmcnt(12)
  ds_read_b128 a[88:91], v32 offset:4096
  v_mul_f32 v115, s27, v115
  v_mfma_f32_16x16x32_bf16 v[140:143], a[140:143], v[80:83], v[140:143]
  ds_read_b64_tr_b16 a[158:159], v27 offset:61440
  v_exp_f32 v115, v115
  v_mfma_f32_16x16x32_bf16 v[172:175], a[140:143], v[84:87], v[172:175]
  s_waitcnt lgkmcnt(11)
  ds_read_b128 a[100:103], v17 offset:0
  v_mul_f32 v120, s27, v120
  v_cvt_pk_bf16_f32 v89, v114, v115
  v_mfma_f32_16x16x32_bf16 v[144:147], a[144:147], v[80:83], v[144:147]
  ds_read_b128 a[104:107], v18 offset:0
  v_exp_f32 v120, v120
  v_mfma_f32_16x16x32_bf16 v[176:179], a[144:147], v[84:87], v[176:179]
  s_waitcnt lgkmcnt(10)
  buffer_store_dwordx4 a[180:183], v40, s[16:19], s74 offen offset:1024 nt
  ds_read_b128 a[92:95], v33 offset:4096
  v_mul_f32 v121, s27, v121
  v_mul_f32 v122, s27, v122
  v_mfma_f32_16x16x32_bf16 v[148:151], a[148:151], v[80:83], v[148:151]
  v_exp_f32 v121, v121
  v_mfma_f32_16x16x32_bf16 v[180:183], a[148:151], v[84:87], v[180:183]
  ds_read_b128 a[108:111], v19 offset:0
  v_cvt_pk_bf16_f32 v92, v120, v121
  v_mfma_f32_16x16x32_bf16 a[228:231], a[240:243], v[84:87], a[228:231]
  s_waitcnt lgkmcnt(8)
  v_exp_f32 v122, v122
  v_mfma_f32_16x16x32_bf16 v[152:155], a[152:155], v[80:83], v[152:155]
  ds_read_b128 a[112:115], v16 offset:4096
  v_mul_f32 v123, s27, v123
  v_exp_f32 v123, v123
  v_mfma_f32_16x16x32_bf16 v[184:187], a[152:155], v[84:87], v[184:187]
  s_waitcnt lgkmcnt(5)
  v_mul_f32 v124, s27, v124
  v_cvt_pk_bf16_f32 v93, v122, v123
  v_mfma_f32_16x16x32_bf16 v[156:159], a[156:159], v[80:83], v[156:159]
  v_exp_f32 v124, v124
  v_mul_f32 v125, s27, v125
  v_mfma_f32_16x16x32_bf16 v[188:191], a[156:159], v[84:87], v[188:191]
  s_waitcnt lgkmcnt(0)
  ds_read_b128 a[116:119], v17 offset:4096
  v_exp_f32 v125, v125
  v_mfma_f32_16x16x32_bf16 v[96:99], a[96:99], a[0:3], 0
  v_mul_f32 v126, s27, v126
  v_cvt_pk_bf16_f32 v94, v124, v125
  v_mfma_f32_16x16x32_bf16 v[96:99], a[100:103], a[4:7], v[96:99]
  ds_read_b128 a[120:123], v18 offset:4096
  v_mul_f32 v127, s27, v127
  v_mfma_f32_16x16x32_bf16 v[96:99], a[104:107], a[8:11], v[96:99]
  v_exp_f32 v126, v126
  v_mfma_f32_16x16x32_bf16 v[96:99], a[108:111], a[12:15], v[96:99]
  v_exp_f32 v127, v127
  v_mfma_f32_16x16x32_bf16 v[104:107], a[108:111], a[28:31], 0
  ds_read_b128 a[124:127], v19 offset:4096
  v_mul_f32 v116, s27, v116
  v_mfma_f32_16x16x32_bf16 v[104:107], a[104:107], a[24:27], v[104:107]
  v_cvt_pk_bf16_f32 v95, v126, v127
  v_mul_f32 v117, s27, v117
  v_mfma_f32_16x16x32_bf16 v[104:107], a[100:103], a[20:23], v[104:107]
  v_exp_f32 v116, v116
  v_mfma_f32_16x16x32_bf16 v[104:107], a[96:99], a[16:19], v[104:107]
  v_exp_f32 v117, v117
  v_mfma_f32_16x16x32_bf16 v[108:111], a[112:115], a[16:19], 0
  s_waitcnt lgkmcnt(2)
  v_mul_f32 v118, s27, v118
  v_cvt_pk_bf16_f32 v90, v116, v117
  v_mfma_f32_16x16x32_bf16 v[108:111], a[116:119], a[20:23], v[108:111]
  s_waitcnt lgkmcnt(1)
  v_exp_f32 v118, v118
  v_mfma_f32_16x16x32_bf16 v[108:111], a[120:123], a[24:27], v[108:111]
  s_waitcnt lgkmcnt(0)
  v_mul_f32 v119, s27, v119
  v_mul_f32 v96, s27, v96
  v_mfma_f32_16x16x32_bf16 v[108:111], a[124:127], a[28:31], v[108:111]
  v_exp_f32 v119, v119
  v_mfma_f32_16x16x32_bf16 v[100:103], a[124:127], a[12:15], 0
  v_cvt_pk_bf16_f32 v91, v118, v119
  v_mul_f32 v97, s27, v97
  v_mfma_f32_16x16x32_bf16 v[100:103], a[120:123], a[8:11], v[100:103]
  v_exp_f32 v96, v96
  v_mfma_f32_16x16x32_bf16 v[100:103], a[116:119], a[4:7], v[100:103]
  s_barrier
  v_exp_f32 v97, v97
  v_mfma_f32_16x16x32_bf16 v[100:103], a[112:115], a[0:3], v[100:103]
  v_mul_f32 v98, s27, v98
  v_cvt_pk_bf16_f32 v80, v96, v97
  v_mfma_f32_16x16x32_bf16 v[192:195], a[128:131], v[88:91], v[192:195]
  s_add_u32 m0, s29, 0
  v_exp_f32 v98, v98
  v_mfma_f32_16x16x32_bf16 v[224:227], a[128:131], v[92:95], v[224:227]
  buffer_load_dwordx4 v28, s[8:11], s21 offen offset:0 nt lds
  v_mfma_f32_16x16x32_bf16 v[196:199], a[132:135], v[88:91], v[196:199]
  ds_read_b64_tr_b16 a[128:129], v20 offset:0
  v_mul_f32 v99, s27, v99
  v_mfma_f32_16x16x32_bf16 v[228:231], a[132:135], v[92:95], v[228:231]
  ds_read_b64_tr_b16 a[130:131], v20 offset:4096
  v_mul_f32 v104, s27, v104
  v_mfma_f32_16x16x32_bf16 v[200:203], a[136:139], v[88:91], v[200:203]
  v_exp_f32 v99, v99
  v_mfma_f32_16x16x32_bf16 v[232:235], a[136:139], v[92:95], v[232:235]
  ds_read_b64_tr_b16 a[132:133], v21 offset:0
  v_cvt_pk_bf16_f32 v81, v98, v99
  v_mfma_f32_16x16x32_bf16 a[232:235], a[240:243], v[88:91], a[232:235]
  v_exp_f32 v104, v104
  v_mfma_f32_16x16x32_bf16 v[204:207], a[140:143], v[88:91], v[204:207]
  ds_read_b64_tr_b16 a[134:135], v21 offset:4096
  v_mul_f32 v105, s27, v105
  v_mfma_f32_16x16x32_bf16 v[236:239], a[140:143], v[92:95], v[236:239]
  v_exp_f32 v105, v105
  v_mfma_f32_16x16x32_bf16 v[208:211], a[144:147], v[88:91], v[208:211]
  buffer_load_dwordx4 v29, s[8:11], s21 offen offset:1024 nt lds
  v_mfma_f32_16x16x32_bf16 v[240:243], a[144:147], v[92:95], v[240:243]
  s_add_u32 s29, s29, 8192
  v_mul_f32 v106, s27, v106
  v_cvt_pk_bf16_f32 v84, v104, v105
  v_mfma_f32_16x16x32_bf16 v[212:215], a[148:151], v[88:91], v[212:215]
  s_and_b32 s29, s29, 0xffff
  v_exp_f32 v106, v106
  v_mfma_f32_16x16x32_bf16 v[244:247], a[148:151], v[92:95], v[244:247]
  s_add_u32 s55, s55, 2048
  ds_read_b64_tr_b16 a[136:137], v22 offset:0
  v_mul_f32 v107, s27, v107
  v_mfma_f32_16x16x32_bf16 a[236:239], a[240:243], v[92:95], a[236:239]
  s_and_b32 s55, s55, 32767
  v_exp_f32 v107, v107
  v_mfma_f32_16x16x32_bf16 v[216:219], a[152:155], v[88:91], v[216:219]
  s_add_u32 s21, s80, s55
  v_mul_f32 v108, s27, v108
  v_cvt_pk_bf16_f32 v85, v106, v107
  v_mfma_f32_16x16x32_bf16 v[248:251], a[152:155], v[92:95], v[248:251]
  ds_read_b64_tr_b16 a[138:139], v22 offset:4096
  v_mul_f32 v109, s27, v109
  v_mfma_f32_16x16x32_bf16 v[220:223], a[156:159], v[88:91], v[220:223]
  s_add_u32 m0, s49, 65536
  v_exp_f32 v108, v108
  v_mfma_f32_16x16x32_bf16 v[252:255], a[156:159], v[92:95], v[252:255]
  buffer_load_dwordx4 v28, s[12:15], s22 offen offset:0 nt lds
  v_mfma_f32_16x16x32_bf16 v[112:115], a[96:99], a[32:35], 0
  ds_read_b64_tr_b16 a[140:141], v23 offset:0
  v_mul_f32 v110, s27, v110
  v_mfma_f32_16x16x32_bf16 v[112:115], a[100:103], a[36:39], v[112:115]
  v_exp_f32 v109, v109
  v_mfma_f32_16x16x32_bf16 v[112:115], a[104:107], a[40:43], v[112:115]
  ds_read_b64_tr_b16 a[142:143], v23 offset:4096
  v_cvt_pk_bf16_f32 v86, v108, v109
  v_mfma_f32_16x16x32_bf16 v[112:115], a[108:111], a[44:47], v[112:115]
  v_exp_f32 v110, v110
  v_mfma_f32_16x16x32_bf16 v[120:123], a[108:111], a[60:63], 0
  ds_read_b64_tr_b16 a[144:145], v24 offset:0
  v_mul_f32 v111, s27, v111
  v_mfma_f32_16x16x32_bf16 v[120:123], a[104:107], a[56:59], v[120:123]
  v_exp_f32 v111, v111
  v_mfma_f32_16x16x32_bf16 v[120:123], a[100:103], a[52:55], v[120:123]
  v_mul_f32 v100, s27, v100
  v_cvt_pk_bf16_f32 v87, v110, v111
  v_mfma_f32_16x16x32_bf16 v[120:123], a[96:99], a[48:51], v[120:123]
  buffer_load_dwordx4 v29, s[12:15], s22 offen offset:1024 nt lds
  v_mfma_f32_16x16x32_bf16 v[124:127], a[112:115], a[48:51], 0
  s_add_u32 s49, s49, 8192
  v_exp_f32 v100, v100
  v_mul_f32 v101, s27, v101
  v_mfma_f32_16x16x32_bf16 v[124:127], a[116:119], a[52:55], v[124:127]
  s_and_b32 s49, s49, 0xffff
  ds_read_b64_tr_b16 a[146:147], v24 offset:4096
  v_mul_f32 v102, s27, v102
  v_mfma_f32_16x16x32_bf16 v[124:127], a[120:123], a[56:59], v[124:127]
  s_add_u32 s56, s56, 2048
  v_exp_f32 v101, v101
  v_mfma_f32_16x16x32_bf16 v[124:127], a[124:127], a[60:63], v[124:127]
  s_and_b32 s56, s56, 32767
  ds_read_b64_tr_b16 a[148:149], v25 offset:0
  v_cvt_pk_bf16_f32 v82, v100, v101
  v_mfma_f32_16x16x32_bf16 v[116:119], a[124:127], a[44:47], 0
  s_add_u32 s22, s81, s56
  ds_read_b64_tr_b16 a[150:151], v25 offset:4096
  v_mul_f32 v103, s27, v103
  v_exp_f32 v102, v102
  v_mfma_f32_16x16x32_bf16 v[116:119], a[120:123], a[40:43], v[116:119]
  v_exp_f32 v103, v103
  v_mfma_f32_16x16x32_bf16 v[116:119], a[116:119], a[36:39], v[116:119]
  ds_read_b64_tr_b16 a[152:153], v26 offset:0
  v_cvt_pk_bf16_f32 v83, v102, v103
  v_mfma_f32_16x16x32_bf16 v[116:119], a[112:115], a[32:35], v[116:119]
  s_waitcnt lgkmcnt(11)
  v_mul_f32 v112, s27, v112
  v_mul_f32 v113, s27, v113
  v_mfma_f32_16x16x32_bf16 v[128:131], a[128:131], v[80:83], v[128:131]
  v_exp_f32 v112, v112
  v_mfma_f32_16x16x32_bf16 v[160:163], a[128:131], v[84:87], v[160:163]
  s_waitcnt lgkmcnt(9)
  ds_read_b64_tr_b16 a[154:155], v26 offset:4096
  ds_read_b64_tr_b16 a[156:157], v27 offset:0
  v_mul_f32 v114, s27, v114
  v_mfma_f32_16x16x32_bf16 v[132:135], a[132:135], v[80:83], v[132:135]
  s_add_u32 m0, s44, 0
  buffer_store_dwordx4 a[184:187], v40, s[16:19], s75 offen offset:0 nt
  ds_read_b128 a[96:99], v16 offset:8192
  v_exp_f32 v113, v113
  v_mfma_f32_16x16x32_bf16 v[164:167], a[132:135], v[84:87], v[164:167]
  s_waitcnt lgkmcnt(10)
  buffer_load_dwordx4 v28, s[4:7], s64 offen offset:0 nt lds
  v_mfma_f32_16x16x32_bf16 v[136:139], a[136:139], v[80:83], v[136:139]
  v_cvt_pk_bf16_f32 v88, v112, v113
  v_mul_f32 v115, s27, v115
  v_mfma_f32_16x16x32_bf16 v[168:171], a[136:139], v[84:87], v[168:171]
  v_exp_f32 v114, v114
  v_mfma_f32_16x16x32_bf16 a[224:227], a[240:243], v[80:83], a[224:227]
  s_waitcnt lgkmcnt(8)
  v_exp_f32 v115, v115
  v_mfma_f32_16x16x32_bf16 v[140:143], a[140:143], v[80:83], v[140:143]
  ds_read_b64_tr_b16 a[158:159], v27 offset:4096
  ds_read_b128 a[100:103], v17 offset:8192
  v_mul_f32 v120, s27, v120
  v_mfma_f32_16x16x32_bf16 v[172:175], a[140:143], v[84:87], v[172:175]
  s_waitcnt lgkmcnt(8)
  ds_read_b128 a[104:107], v18 offset:8192
  v_cvt_pk_bf16_f32 v89, v114, v115
  v_mul_f32 v121, s27, v121
  v_mfma_f32_16x16x32_bf16 v[144:147], a[144:147], v[80:83], v[144:147]
  ds_read_b128 a[108:111], v19 offset:8192
  v_exp_f32 v120, v120
  v_mfma_f32_16x16x32_bf16 v[176:179], a[144:147], v[84:87], v[176:179]
  s_waitcnt lgkmcnt(8)
  buffer_store_dwordx4 a[188:191], v40, s[16:19], s75 offen offset:1024 nt
  v_exp_f32 v121, v121
  v_mul_f32 v122, s27, v122
  v_mfma_f32_16x16x32_bf16 v[148:151], a[148:151], v[80:83], v[148:151]
  buffer_load_dwordx4 v29, s[4:7], s64 offen offset:1024 nt lds
  v_mfma_f32_16x16x32_bf16 v[180:183], a[148:151], v[84:87], v[180:183]
  v_cvt_pk_bf16_f32 v92, v120, v121
  v_mul_f32 v123, s27, v123
  v_mfma_f32_16x16x32_bf16 a[228:231], a[240:243], v[84:87], a[228:231]
  s_waitcnt lgkmcnt(6)
  v_exp_f32 v122, v122
  v_mfma_f32_16x16x32_bf16 v[152:155], a[152:155], v[80:83], v[152:155]
  v_exp_f32 v123, v123
  v_mfma_f32_16x16x32_bf16 v[184:187], a[152:155], v[84:87], v[184:187]
  s_waitcnt lgkmcnt(3)
  ds_read_b128 a[112:115], v16 offset:12288
  v_mul_f32 v124, s27, v124
  v_cvt_pk_bf16_f32 v93, v122, v123
  v_mfma_f32_16x16x32_bf16 v[156:159], a[156:159], v[80:83], v[156:159]
  v_exp_f32 v124, v124
  v_mul_f32 v125, s27, v125
  v_mfma_f32_16x16x32_bf16 v[188:191], a[156:159], v[84:87], v[188:191]
  ds_read_b128 a[116:119], v17 offset:12288
  v_exp_f32 v125, v125
  v_mfma_f32_16x16x32_bf16 v[96:99], a[96:99], a[0:3], 0
  s_waitcnt lgkmcnt(4)
  v_mul_f32 v126, s27, v126
  v_cvt_pk_bf16_f32 v94, v124, v125
  v_mfma_f32_16x16x32_bf16 v[96:99], a[100:103], a[4:7], v[96:99]
  s_waitcnt lgkmcnt(3)
  ds_read_b128 a[120:123], v18 offset:12288
  v_mul_f32 v127, s27, v127
  v_mfma_f32_16x16x32_bf16 v[96:99], a[104:107], a[8:11], v[96:99]
  s_waitcnt lgkmcnt(3)
  v_exp_f32 v126, v126
  v_mfma_f32_16x16x32_bf16 v[96:99], a[108:111], a[12:15], v[96:99]
  v_exp_f32 v127, v127
  v_mfma_f32_16x16x32_bf16 v[104:107], a[108:111], a[28:31], 0
  ds_read_b128 a[124:127], v19 offset:12288
  v_mul_f32 v116, s27, v116
  v_mfma_f32_16x16x32_bf16 v[104:107], a[104:107], a[24:27], v[104:107]
  v_cvt_pk_bf16_f32 v95, v126, v127
  v_mul_f32 v117, s27, v117
  v_mfma_f32_16x16x32_bf16 v[104:107], a[100:103], a[20:23], v[104:107]
  s_add_u32 m0, s29, 0
  v_exp_f32 v116, v116
  v_mfma_f32_16x16x32_bf16 v[104:107], a[96:99], a[16:19], v[104:107]
  s_waitcnt lgkmcnt(3)
  v_exp_f32 v117, v117
  v_mfma_f32_16x16x32_bf16 v[108:111], a[112:115], a[16:19], 0
  s_waitcnt lgkmcnt(2)
  v_mul_f32 v118, s27, v118
  v_cvt_pk_bf16_f32 v90, v116, v117
  v_mfma_f32_16x16x32_bf16 v[108:111], a[116:119], a[20:23], v[108:111]
  s_waitcnt lgkmcnt(1)
  buffer_load_dwordx4 v28, s[8:11], s21 offen offset:0 nt lds
  v_mfma_f32_16x16x32_bf16 v[108:111], a[120:123], a[24:27], v[108:111]
  s_waitcnt lgkmcnt(0)
  v_exp_f32 v118, v118
  v_mfma_f32_16x16x32_bf16 v[108:111], a[124:127], a[28:31], v[108:111]
  v_mul_f32 v119, s27, v119
  v_mul_f32 v96, s27, v96
  v_mfma_f32_16x16x32_bf16 v[100:103], a[124:127], a[12:15], 0
  v_exp_f32 v119, v119
  v_mfma_f32_16x16x32_bf16 v[100:103], a[120:123], a[8:11], v[100:103]
  v_cvt_pk_bf16_f32 v91, v118, v119
  v_mul_f32 v97, s27, v97
  v_mfma_f32_16x16x32_bf16 v[100:103], a[116:119], a[4:7], v[100:103]
  v_exp_f32 v96, v96
  v_mfma_f32_16x16x32_bf16 v[100:103], a[112:115], a[0:3], v[100:103]
  v_exp_f32 v97, v97
  v_mfma_f32_16x16x32_bf16 v[192:195], a[128:131], v[88:91], v[192:195]
  v_mul_f32 v98, s27, v98
  v_cvt_pk_bf16_f32 v80, v96, v97
  v_mfma_f32_16x16x32_bf16 v[224:227], a[128:131], v[92:95], v[224:227]
  buffer_load_dwordx4 v29, s[8:11], s21 offen offset:1024 nt lds
  v_mfma_f32_16x16x32_bf16 v[196:199], a[132:135], v[88:91], v[196:199]
  s_add_u32 s29, s29, 8192
  ds_read_b64_tr_b16 a[128:129], v20 offset:8192
  v_mul_f32 v99, s27, v99
  v_mfma_f32_16x16x32_bf16 v[228:231], a[132:135], v[92:95], v[228:231]
  s_and_b32 s29, s29, 0xffff
  v_exp_f32 v98, v98
  v_mfma_f32_16x16x32_bf16 v[200:203], a[136:139], v[88:91], v[200:203]
  s_add_u32 s55, s55, 2048
  ds_read_b64_tr_b16 a[130:131], v20 offset:12288
  v_mul_f32 v104, s27, v104
  v_mfma_f32_16x16x32_bf16 v[232:235], a[136:139], v[92:95], v[232:235]
  s_and_b32 s55, s55, 32767
  v_exp_f32 v99, v99
  v_mfma_f32_16x16x32_bf16 a[232:235], a[240:243], v[88:91], a[232:235]
  s_add_u32 s21, s80, s55
  ds_read_b64_tr_b16 a[132:133], v21 offset:8192
  v_cvt_pk_bf16_f32 v81, v98, v99
  v_mfma_f32_16x16x32_bf16 v[204:207], a[140:143], v[88:91], v[204:207]
  v_exp_f32 v104, v104
  v_mfma_f32_16x16x32_bf16 v[236:239], a[140:143], v[92:95], v[236:239]
  s_add_u32 m0, s49, 65536
  ds_read_b64_tr_b16 a[134:135], v21 offset:12288
  v_mul_f32 v105, s27, v105
  v_mfma_f32_16x16x32_bf16 v[208:211], a[144:147], v[88:91], v[208:211]
  buffer_load_dwordx4 v28, s[12:15], s22 offen offset:0 nt lds
  v_mfma_f32_16x16x32_bf16 v[240:243], a[144:147], v[92:95], v[240:243]
  v_exp_f32 v105, v105
  v_mfma_f32_16x16x32_bf16 v[212:215], a[148:151], v[88:91], v[212:215]
  v_mul_f32 v106, s27, v106
  v_cvt_pk_bf16_f32 v84, v104, v105
  v_mfma_f32_16x16x32_bf16 v[244:247], a[148:151], v[92:95], v[244:247]
  v_exp_f32 v106, v106
  v_mfma_f32_16x16x32_bf16 a[236:239], a[240:243], v[92:95], a[236:239]
  ds_read_b64_tr_b16 a[136:137], v22 offset:8192
  v_mul_f32 v107, s27, v107
  v_mfma_f32_16x16x32_bf16 v[216:219], a[152:155], v[88:91], v[216:219]
  v_exp_f32 v107, v107
  v_mfma_f32_16x16x32_bf16 v[248:251], a[152:155], v[92:95], v[248:251]
  v_mul_f32 v108, s27, v108
  v_cvt_pk_bf16_f32 v85, v106, v107
  v_mfma_f32_16x16x32_bf16 v[220:223], a[156:159], v[88:91], v[220:223]
  ds_read_b64_tr_b16 a[138:139], v22 offset:12288
  v_mul_f32 v109, s27, v109
  v_mfma_f32_16x16x32_bf16 v[252:255], a[156:159], v[92:95], v[252:255]
  buffer_load_dwordx4 v29, s[12:15], s22 offen offset:1024 nt lds
  v_mfma_f32_16x16x32_bf16 v[112:115], a[96:99], a[32:35], 0
  s_add_u32 s49, s49, 8192
  v_exp_f32 v108, v108
  v_mfma_f32_16x16x32_bf16 v[112:115], a[100:103], a[36:39], v[112:115]
  s_and_b32 s49, s49, 0xffff
  ds_read_b64_tr_b16 a[140:141], v23 offset:8192
  v_mul_f32 v110, s27, v110
  v_mfma_f32_16x16x32_bf16 v[112:115], a[104:107], a[40:43], v[112:115]
  s_add_u32 s56, s56, 2048
  v_exp_f32 v109, v109
  v_mfma_f32_16x16x32_bf16 v[112:115], a[108:111], a[44:47], v[112:115]
  s_and_b32 s56, s56, 32767
  ds_read_b64_tr_b16 a[142:143], v23 offset:12288
  v_cvt_pk_bf16_f32 v86, v108, v109
  v_mfma_f32_16x16x32_bf16 v[120:123], a[108:111], a[60:63], 0
  s_add_u32 s22, s81, s56
  v_exp_f32 v110, v110
  v_mul_f32 v111, s27, v111
  v_mfma_f32_16x16x32_bf16 v[120:123], a[104:107], a[56:59], v[120:123]
  v_exp_f32 v111, v111
  v_mfma_f32_16x16x32_bf16 v[120:123], a[100:103], a[52:55], v[120:123]
  ds_read_b64_tr_b16 a[144:145], v24 offset:8192
  v_mul_f32 v100, s27, v100
  v_cvt_pk_bf16_f32 v87, v110, v111
  v_mfma_f32_16x16x32_bf16 v[120:123], a[96:99], a[48:51], v[120:123]
  v_exp_f32 v100, v100
  v_mfma_f32_16x16x32_bf16 v[124:127], a[112:115], a[48:51], 0
  ds_read_b64_tr_b16 a[146:147], v24 offset:12288
  v_mul_f32 v101, s27, v101
  v_mfma_f32_16x16x32_bf16 v[124:127], a[116:119], a[52:55], v[124:127]
  v_exp_f32 v101, v101
  v_mfma_f32_16x16x32_bf16 v[124:127], a[120:123], a[56:59], v[124:127]
  v_mul_f32 v102, s27, v102
  v_cvt_pk_bf16_f32 v82, v100, v101
  v_mfma_f32_16x16x32_bf16 v[124:127], a[124:127], a[60:63], v[124:127]
  ds_read_b64_tr_b16 a[148:149], v25 offset:8192
  v_mul_f32 v103, s27, v103
  v_mfma_f32_16x16x32_bf16 v[116:119], a[124:127], a[44:47], 0
  v_exp_f32 v102, v102
  v_mfma_f32_16x16x32_bf16 v[116:119], a[120:123], a[40:43], v[116:119]
  ds_read_b64_tr_b16 a[150:151], v25 offset:12288
  v_exp_f32 v103, v103
  v_mfma_f32_16x16x32_bf16 v[116:119], a[116:119], a[36:39], v[116:119]
  ds_read_b64_tr_b16 a[152:153], v26 offset:8192
  v_cvt_pk_bf16_f32 v83, v102, v103
  v_mfma_f32_16x16x32_bf16 v[116:119], a[112:115], a[32:35], v[116:119]
  s_waitcnt lgkmcnt(11)
  v_mul_f32 v112, s27, v112
  v_mul_f32 v113, s27, v113
  v_mfma_f32_16x16x32_bf16 v[128:131], a[128:131], v[80:83], v[128:131]
  s_add_u32 m0, s44, 2048
  v_exp_f32 v112, v112
  v_mfma_f32_16x16x32_bf16 v[160:163], a[128:131], v[84:87], v[160:163]
  s_waitcnt lgkmcnt(9)
  ds_read_b64_tr_b16 a[154:155], v26 offset:12288
  v_mul_f32 v114, s27, v114
  v_mfma_f32_16x16x32_bf16 v[132:135], a[132:135], v[80:83], v[132:135]
  buffer_load_dwordx4 v28, s[4:7], s65 offen offset:0 nt lds
  v_mfma_f32_16x16x32_bf16 v[164:167], a[132:135], v[84:87], v[164:167]
  s_waitcnt lgkmcnt(8)
  v_exp_f32 v113, v113
  v_mfma_f32_16x16x32_bf16 v[136:139], a[136:139], v[80:83], v[136:139]
  ds_read_b64_tr_b16 a[156:157], v27 offset:8192
  v_cvt_pk_bf16_f32 v88, v112, v113
  v_mfma_f32_16x16x32_bf16 v[168:171], a[136:139], v[84:87], v[168:171]
  v_exp_f32 v114, v114
  v_mfma_f32_16x16x32_bf16 a[224:227], a[240:243], v[80:83], a[224:227]
  s_waitcnt lgkmcnt(7)
  ds_read_b128 a[96:99], v16 offset:16384
  v_mul_f32 v115, s27, v115
  v_mfma_f32_16x16x32_bf16 v[140:143], a[140:143], v[80:83], v[140:143]
  ds_read_b64_tr_b16 a[158:159], v27 offset:12288
  v_exp_f32 v115, v115
  v_mfma_f32_16x16x32_bf16 v[172:175], a[140:143], v[84:87], v[172:175]
  s_waitcnt lgkmcnt(7)
  ds_read_b128 a[100:103], v17 offset:16384
  v_mul_f32 v120, s27, v120
  v_cvt_pk_bf16_f32 v89, v114, v115
  v_mfma_f32_16x16x32_bf16 v[144:147], a[144:147], v[80:83], v[144:147]
  v_exp_f32 v120, v120
  v_mfma_f32_16x16x32_bf16 v[176:179], a[144:147], v[84:87], v[176:179]
  s_waitcnt lgkmcnt(6)
  buffer_load_dwordx4 v29, s[4:7], s65 offen offset:1024 nt lds
  v_mfma_f32_16x16x32_bf16 v[148:151], a[148:151], v[80:83], v[148:151]
  ds_read_b128 a[104:107], v18 offset:16384
  ds_read_b128 a[108:111], v19 offset:16384
  v_mul_f32 v121, s27, v121
  v_mfma_f32_16x16x32_bf16 v[180:183], a[148:151], v[84:87], v[180:183]
  v_exp_f32 v121, v121
  v_mul_f32 v122, s27, v122
  v_mfma_f32_16x16x32_bf16 a[228:231], a[240:243], v[84:87], a[228:231]
  s_waitcnt lgkmcnt(6)
  v_cvt_pk_bf16_f32 v92, v120, v121
  v_mul_f32 v123, s27, v123
  v_exp_f32 v122, v122
  v_mfma_f32_16x16x32_bf16 v[152:155], a[152:155], v[80:83], v[152:155]
  v_exp_f32 v123, v123
  v_mfma_f32_16x16x32_bf16 v[184:187], a[152:155], v[84:87], v[184:187]
  s_waitcnt lgkmcnt(3)
  ds_read_b128 a[112:115], v16 offset:20480
  v_mul_f32 v124, s27, v124
  v_cvt_pk_bf16_f32 v93, v122, v123
  v_mfma_f32_16x16x32_bf16 v[156:159], a[156:159], v[80:83], v[156:159]
  v_exp_f32 v124, v124
  v_mul_f32 v125, s27, v125
  v_mfma_f32_16x16x32_bf16 v[188:191], a[156:159], v[84:87], v[188:191]
  ds_read_b128 a[116:119], v17 offset:20480
  v_exp_f32 v125, v125
  v_mfma_f32_16x16x32_bf16 v[96:99], a[96:99], a[0:3], 0
  s_waitcnt lgkmcnt(4)
  v_mul_f32 v126, s27, v126
  v_cvt_pk_bf16_f32 v94, v124, v125
  v_mfma_f32_16x16x32_bf16 v[96:99], a[100:103], a[4:7], v[96:99]
  s_waitcnt lgkmcnt(3)
  ds_read_b128 a[120:123], v18 offset:20480
  v_mul_f32 v127, s27, v127
  v_mfma_f32_16x16x32_bf16 v[96:99], a[104:107], a[8:11], v[96:99]
  s_waitcnt lgkmcnt(3)
  v_exp_f32 v126, v126
  v_mfma_f32_16x16x32_bf16 v[96:99], a[108:111], a[12:15], v[96:99]
  v_exp_f32 v127, v127
  v_mfma_f32_16x16x32_bf16 v[104:107], a[108:111], a[28:31], 0
  ds_read_b128 a[124:127], v19 offset:20480
  v_mul_f32 v116, s27, v116
  v_mfma_f32_16x16x32_bf16 v[104:107], a[104:107], a[24:27], v[104:107]
  v_cvt_pk_bf16_f32 v95, v126, v127
  v_mul_f32 v117, s27, v117
  v_mfma_f32_16x16x32_bf16 v[104:107], a[100:103], a[20:23], v[104:107]
  v_exp_f32 v116, v116
  v_mfma_f32_16x16x32_bf16 v[104:107], a[96:99], a[16:19], v[104:107]
  s_waitcnt lgkmcnt(3)
  v_exp_f32 v117, v117
  v_mfma_f32_16x16x32_bf16 v[108:111], a[112:115], a[16:19], 0
  s_waitcnt lgkmcnt(2)
  v_mul_f32 v118, s27, v118
  v_cvt_pk_bf16_f32 v90, v116, v117
  v_mfma_f32_16x16x32_bf16 v[108:111], a[116:119], a[20:23], v[108:111]
  s_waitcnt lgkmcnt(1)
  v_exp_f32 v118, v118
  v_mfma_f32_16x16x32_bf16 v[108:111], a[120:123], a[24:27], v[108:111]
  s_waitcnt lgkmcnt(0)
  v_mul_f32 v119, s27, v119
  v_mul_f32 v96, s27, v96
  v_mfma_f32_16x16x32_bf16 v[108:111], a[124:127], a[28:31], v[108:111]
  v_exp_f32 v119, v119
  v_mfma_f32_16x16x32_bf16 v[100:103], a[124:127], a[12:15], 0
  v_cvt_pk_bf16_f32 v91, v118, v119
  v_mul_f32 v97, s27, v97
  v_mfma_f32_16x16x32_bf16 v[100:103], a[120:123], a[8:11], v[100:103]
  s_waitcnt vmcnt(16)
  v_exp_f32 v96, v96
  v_mfma_f32_16x16x32_bf16 v[100:103], a[116:119], a[4:7], v[100:103]
  s_barrier
  v_exp_f32 v97, v97
  v_mfma_f32_16x16x32_bf16 v[100:103], a[112:115], a[0:3], v[100:103]
  v_mul_f32 v98, s27, v98
  v_cvt_pk_bf16_f32 v80, v96, v97
  v_mfma_f32_16x16x32_bf16 v[192:195], a[128:131], v[88:91], v[192:195]
  s_add_u32 m0, s29, 0
  v_exp_f32 v98, v98
  v_mfma_f32_16x16x32_bf16 v[224:227], a[128:131], v[92:95], v[224:227]
  buffer_load_dwordx4 v28, s[8:11], s21 offen offset:0 nt lds
  v_mfma_f32_16x16x32_bf16 v[196:199], a[132:135], v[88:91], v[196:199]
  ds_read_b64_tr_b16 a[128:129], v20 offset:16384
  v_mul_f32 v99, s27, v99
  v_mfma_f32_16x16x32_bf16 v[228:231], a[132:135], v[92:95], v[228:231]
  ds_read_b64_tr_b16 a[130:131], v20 offset:20480
  v_mul_f32 v104, s27, v104
  v_mfma_f32_16x16x32_bf16 v[200:203], a[136:139], v[88:91], v[200:203]
  v_exp_f32 v99, v99
  v_mfma_f32_16x16x32_bf16 v[232:235], a[136:139], v[92:95], v[232:235]
  ds_read_b64_tr_b16 a[132:133], v21 offset:16384
  v_cvt_pk_bf16_f32 v81, v98, v99
  v_mfma_f32_16x16x32_bf16 a[232:235], a[240:243], v[88:91], a[232:235]
  v_exp_f32 v104, v104
  v_mfma_f32_16x16x32_bf16 v[204:207], a[140:143], v[88:91], v[204:207]
  ds_read_b64_tr_b16 a[134:135], v21 offset:20480
  v_mul_f32 v105, s27, v105
  v_mfma_f32_16x16x32_bf16 v[236:239], a[140:143], v[92:95], v[236:239]
  v_exp_f32 v105, v105
  v_mfma_f32_16x16x32_bf16 v[208:211], a[144:147], v[88:91], v[208:211]
  buffer_load_dwordx4 v29, s[8:11], s21 offen offset:1024 nt lds
  v_mfma_f32_16x16x32_bf16 v[240:243], a[144:147], v[92:95], v[240:243]
  s_add_u32 s29, s29, 8192
  v_mul_f32 v106, s27, v106
  v_cvt_pk_bf16_f32 v84, v104, v105
  v_mfma_f32_16x16x32_bf16 v[212:215], a[148:151], v[88:91], v[212:215]
  s_and_b32 s29, s29, 0xffff
  v_exp_f32 v106, v106
  v_mfma_f32_16x16x32_bf16 v[244:247], a[148:151], v[92:95], v[244:247]
  s_add_u32 s55, s55, 2048
  ds_read_b64_tr_b16 a[136:137], v22 offset:16384
  v_mul_f32 v107, s27, v107
  v_mfma_f32_16x16x32_bf16 a[236:239], a[240:243], v[92:95], a[236:239]
  s_and_b32 s55, s55, 32767
  v_exp_f32 v107, v107
  v_mfma_f32_16x16x32_bf16 v[216:219], a[152:155], v[88:91], v[216:219]
  s_add_u32 s80, s80, 16777216
  v_mul_f32 v108, s27, v108
  v_cvt_pk_bf16_f32 v85, v106, v107
  v_mfma_f32_16x16x32_bf16 v[248:251], a[152:155], v[92:95], v[248:251]
  s_add_u32 s21, s80, s55
  ds_read_b64_tr_b16 a[138:139], v22 offset:20480
  v_mul_f32 v109, s27, v109
  v_mfma_f32_16x16x32_bf16 v[220:223], a[156:159], v[88:91], v[220:223]
  s_add_u32 m0, s49, 65536
  v_exp_f32 v108, v108
  v_mfma_f32_16x16x32_bf16 v[252:255], a[156:159], v[92:95], v[252:255]
  buffer_load_dwordx4 v28, s[12:15], s22 offen offset:0 nt lds
  v_mfma_f32_16x16x32_bf16 v[112:115], a[96:99], a[32:35], 0
  ds_read_b64_tr_b16 a[140:141], v23 offset:16384
  v_mul_f32 v110, s27, v110
  v_mfma_f32_16x16x32_bf16 v[112:115], a[100:103], a[36:39], v[112:115]
  v_exp_f32 v109, v109
  v_mfma_f32_16x16x32_bf16 v[112:115], a[104:107], a[40:43], v[112:115]
  ds_read_b64_tr_b16 a[142:143], v23 offset:20480
  v_cvt_pk_bf16_f32 v86, v108, v109
  v_mfma_f32_16x16x32_bf16 v[112:115], a[108:111], a[44:47], v[112:115]
  v_exp_f32 v110, v110
  v_mfma_f32_16x16x32_bf16 v[120:123], a[108:111], a[60:63], 0
  ds_read_b64_tr_b16 a[144:145], v24 offset:16384
  v_mul_f32 v111, s27, v111
  v_mfma_f32_16x16x32_bf16 v[120:123], a[104:107], a[56:59], v[120:123]
  v_exp_f32 v111, v111
  v_mfma_f32_16x16x32_bf16 v[120:123], a[100:103], a[52:55], v[120:123]
  v_mul_f32 v100, s27, v100
  v_cvt_pk_bf16_f32 v87, v110, v111
  v_mfma_f32_16x16x32_bf16 v[120:123], a[96:99], a[48:51], v[120:123]
  buffer_load_dwordx4 v29, s[12:15], s22 offen offset:1024 nt lds
  v_mfma_f32_16x16x32_bf16 v[124:127], a[112:115], a[48:51], 0
  s_add_u32 s49, s49, 8192
  v_exp_f32 v100, v100
  v_mul_f32 v101, s27, v101
  v_mfma_f32_16x16x32_bf16 v[124:127], a[116:119], a[52:55], v[124:127]
  s_and_b32 s49, s49, 0xffff
  ds_read_b64_tr_b16 a[146:147], v24 offset:20480
  v_mul_f32 v102, s27, v102
  v_mfma_f32_16x16x32_bf16 v[124:127], a[120:123], a[56:59], v[124:127]
  s_add_u32 s56, s56, 2048
  v_exp_f32 v101, v101
  v_mfma_f32_16x16x32_bf16 v[124:127], a[124:127], a[60:63], v[124:127]
  s_and_b32 s56, s56, 32767
  ds_read_b64_tr_b16 a[148:149], v25 offset:16384
  v_cvt_pk_bf16_f32 v82, v100, v101
  v_mfma_f32_16x16x32_bf16 v[116:119], a[124:127], a[44:47], 0
  s_add_u32 s22, s81, s56
  ds_read_b64_tr_b16 a[150:151], v25 offset:20480
  v_mul_f32 v103, s27, v103
  v_exp_f32 v102, v102
  v_mfma_f32_16x16x32_bf16 v[116:119], a[120:123], a[40:43], v[116:119]
  v_exp_f32 v103, v103
  v_mfma_f32_16x16x32_bf16 v[116:119], a[116:119], a[36:39], v[116:119]
  ds_read_b64_tr_b16 a[152:153], v26 offset:16384
  v_cvt_pk_bf16_f32 v83, v102, v103
  v_mfma_f32_16x16x32_bf16 v[116:119], a[112:115], a[32:35], v[116:119]
  s_waitcnt lgkmcnt(11)
  v_mul_f32 v112, s27, v112
  v_mul_f32 v113, s27, v113
  v_mfma_f32_16x16x32_bf16 v[128:131], a[128:131], v[80:83], v[128:131]
  s_add_u32 m0, s44, 4096
  v_exp_f32 v112, v112
  v_mfma_f32_16x16x32_bf16 v[160:163], a[128:131], v[84:87], v[160:163]
  s_waitcnt lgkmcnt(9)
  ds_read_b64_tr_b16 a[154:155], v26 offset:20480
  v_mul_f32 v114, s27, v114
  v_mfma_f32_16x16x32_bf16 v[132:135], a[132:135], v[80:83], v[132:135]
  buffer_load_dwordx4 v28, s[4:7], s66 offen offset:0 nt lds
  v_mfma_f32_16x16x32_bf16 v[164:167], a[132:135], v[84:87], v[164:167]
  s_waitcnt lgkmcnt(8)
  v_exp_f32 v113, v113
  v_mfma_f32_16x16x32_bf16 v[136:139], a[136:139], v[80:83], v[136:139]
  ds_read_b64_tr_b16 a[156:157], v27 offset:16384
  v_cvt_pk_bf16_f32 v88, v112, v113
  v_mfma_f32_16x16x32_bf16 v[168:171], a[136:139], v[84:87], v[168:171]
  v_exp_f32 v114, v114
  v_mfma_f32_16x16x32_bf16 a[224:227], a[240:243], v[80:83], a[224:227]
  s_waitcnt lgkmcnt(7)
  ds_read_b128 a[96:99], v16 offset:24576
  v_mul_f32 v115, s27, v115
  v_mfma_f32_16x16x32_bf16 v[140:143], a[140:143], v[80:83], v[140:143]
  ds_read_b64_tr_b16 a[158:159], v27 offset:20480
  v_exp_f32 v115, v115
  v_mfma_f32_16x16x32_bf16 v[172:175], a[140:143], v[84:87], v[172:175]
  s_waitcnt lgkmcnt(7)
  ds_read_b128 a[100:103], v17 offset:24576
  v_mul_f32 v120, s27, v120
  v_cvt_pk_bf16_f32 v89, v114, v115
  v_mfma_f32_16x16x32_bf16 v[144:147], a[144:147], v[80:83], v[144:147]
  v_exp_f32 v120, v120
  v_mfma_f32_16x16x32_bf16 v[176:179], a[144:147], v[84:87], v[176:179]
  s_waitcnt lgkmcnt(6)
  buffer_load_dwordx4 v29, s[4:7], s66 offen offset:1024 nt lds
  v_mfma_f32_16x16x32_bf16 v[148:151], a[148:151], v[80:83], v[148:151]
  ds_read_b128 a[104:107], v18 offset:24576
  ds_read_b128 a[108:111], v19 offset:24576
  v_mul_f32 v121, s27, v121
  v_mfma_f32_16x16x32_bf16 v[180:183], a[148:151], v[84:87], v[180:183]
  v_exp_f32 v121, v121
  v_mul_f32 v122, s27, v122
  v_mfma_f32_16x16x32_bf16 a[228:231], a[240:243], v[84:87], a[228:231]
  s_waitcnt lgkmcnt(6)
  v_cvt_pk_bf16_f32 v92, v120, v121
  v_mul_f32 v123, s27, v123
  v_exp_f32 v122, v122
  v_mfma_f32_16x16x32_bf16 v[152:155], a[152:155], v[80:83], v[152:155]
  v_exp_f32 v123, v123
  v_mfma_f32_16x16x32_bf16 v[184:187], a[152:155], v[84:87], v[184:187]
  s_waitcnt lgkmcnt(3)
  ds_read_b128 a[112:115], v16 offset:28672
  v_mul_f32 v124, s27, v124
  v_cvt_pk_bf16_f32 v93, v122, v123
  v_mfma_f32_16x16x32_bf16 v[156:159], a[156:159], v[80:83], v[156:159]
  v_exp_f32 v124, v124
  v_mul_f32 v125, s27, v125
  v_mfma_f32_16x16x32_bf16 v[188:191], a[156:159], v[84:87], v[188:191]
  ds_read_b128 a[116:119], v17 offset:28672
  v_exp_f32 v125, v125
  v_mfma_f32_16x16x32_bf16 v[96:99], a[96:99], a[0:3], 0
  s_waitcnt lgkmcnt(4)
  v_mul_f32 v126, s27, v126
  v_cvt_pk_bf16_f32 v94, v124, v125
  v_mfma_f32_16x16x32_bf16 v[96:99], a[100:103], a[4:7], v[96:99]
  s_waitcnt lgkmcnt(3)
  ds_read_b128 a[120:123], v18 offset:28672
  v_mul_f32 v127, s27, v127
  v_mfma_f32_16x16x32_bf16 v[96:99], a[104:107], a[8:11], v[96:99]
  s_waitcnt lgkmcnt(3)
  v_exp_f32 v126, v126
  v_mfma_f32_16x16x32_bf16 v[96:99], a[108:111], a[12:15], v[96:99]
  v_exp_f32 v127, v127
  v_mfma_f32_16x16x32_bf16 v[104:107], a[108:111], a[28:31], 0
  ds_read_b128 a[124:127], v19 offset:28672
  v_mul_f32 v116, s27, v116
  v_mfma_f32_16x16x32_bf16 v[104:107], a[104:107], a[24:27], v[104:107]
  v_cvt_pk_bf16_f32 v95, v126, v127
  v_mul_f32 v117, s27, v117
  v_mfma_f32_16x16x32_bf16 v[104:107], a[100:103], a[20:23], v[104:107]
  s_add_u32 m0, s29, 0
  v_exp_f32 v116, v116
  v_mfma_f32_16x16x32_bf16 v[104:107], a[96:99], a[16:19], v[104:107]
  s_waitcnt lgkmcnt(3)
  v_exp_f32 v117, v117
  v_mfma_f32_16x16x32_bf16 v[108:111], a[112:115], a[16:19], 0
  s_waitcnt lgkmcnt(2)
  v_mul_f32 v118, s27, v118
  v_cvt_pk_bf16_f32 v90, v116, v117
  v_mfma_f32_16x16x32_bf16 v[108:111], a[116:119], a[20:23], v[108:111]
  s_waitcnt lgkmcnt(1)
  buffer_load_dwordx4 v28, s[8:11], s21 offen offset:0 nt lds
  v_mfma_f32_16x16x32_bf16 v[108:111], a[120:123], a[24:27], v[108:111]
  s_waitcnt lgkmcnt(0)
  v_exp_f32 v118, v118
  v_mfma_f32_16x16x32_bf16 v[108:111], a[124:127], a[28:31], v[108:111]
  v_mul_f32 v119, s27, v119
  v_mul_f32 v96, s27, v96
  v_mfma_f32_16x16x32_bf16 v[100:103], a[124:127], a[12:15], 0
  v_exp_f32 v119, v119
  v_mfma_f32_16x16x32_bf16 v[100:103], a[120:123], a[8:11], v[100:103]
  v_cvt_pk_bf16_f32 v91, v118, v119
  v_mul_f32 v97, s27, v97
  v_mfma_f32_16x16x32_bf16 v[100:103], a[116:119], a[4:7], v[100:103]
  v_exp_f32 v96, v96
  v_mfma_f32_16x16x32_bf16 v[100:103], a[112:115], a[0:3], v[100:103]
  v_exp_f32 v97, v97
  v_mfma_f32_16x16x32_bf16 v[192:195], a[128:131], v[88:91], v[192:195]
  v_mul_f32 v98, s27, v98
  v_cvt_pk_bf16_f32 v80, v96, v97
  v_mfma_f32_16x16x32_bf16 v[224:227], a[128:131], v[92:95], v[224:227]
  buffer_load_dwordx4 v29, s[8:11], s21 offen offset:1024 nt lds
  v_mfma_f32_16x16x32_bf16 v[196:199], a[132:135], v[88:91], v[196:199]
  s_add_u32 s29, s29, 8192
  ds_read_b64_tr_b16 a[128:129], v20 offset:24576
  v_mul_f32 v99, s27, v99
  v_mfma_f32_16x16x32_bf16 v[228:231], a[132:135], v[92:95], v[228:231]
  s_and_b32 s29, s29, 0xffff
  v_exp_f32 v98, v98
  v_mfma_f32_16x16x32_bf16 v[200:203], a[136:139], v[88:91], v[200:203]
  s_add_u32 s55, s55, 2048
  ds_read_b64_tr_b16 a[130:131], v20 offset:28672
  v_mul_f32 v104, s27, v104
  v_mfma_f32_16x16x32_bf16 v[232:235], a[136:139], v[92:95], v[232:235]
  s_and_b32 s55, s55, 32767
  v_exp_f32 v99, v99
  v_mfma_f32_16x16x32_bf16 a[232:235], a[240:243], v[88:91], a[232:235]
  s_add_u32 s21, s80, s55
  ds_read_b64_tr_b16 a[132:133], v21 offset:24576
  v_cvt_pk_bf16_f32 v81, v98, v99
  v_mfma_f32_16x16x32_bf16 v[204:207], a[140:143], v[88:91], v[204:207]
  v_exp_f32 v104, v104
  v_mfma_f32_16x16x32_bf16 v[236:239], a[140:143], v[92:95], v[236:239]
  s_add_u32 m0, s49, 65536
  ds_read_b64_tr_b16 a[134:135], v21 offset:28672
  v_mul_f32 v105, s27, v105
  v_mfma_f32_16x16x32_bf16 v[208:211], a[144:147], v[88:91], v[208:211]
  buffer_load_dwordx4 v28, s[12:15], s22 offen offset:0 nt lds
  v_mfma_f32_16x16x32_bf16 v[240:243], a[144:147], v[92:95], v[240:243]
  v_exp_f32 v105, v105
  v_mfma_f32_16x16x32_bf16 v[212:215], a[148:151], v[88:91], v[212:215]
  v_mul_f32 v106, s27, v106
  v_cvt_pk_bf16_f32 v84, v104, v105
  v_mfma_f32_16x16x32_bf16 v[244:247], a[148:151], v[92:95], v[244:247]
  v_exp_f32 v106, v106
  v_mfma_f32_16x16x32_bf16 a[236:239], a[240:243], v[92:95], a[236:239]
  ds_read_b64_tr_b16 a[136:137], v22 offset:24576
  v_mul_f32 v107, s27, v107
  v_mfma_f32_16x16x32_bf16 v[216:219], a[152:155], v[88:91], v[216:219]
  v_exp_f32 v107, v107
  v_mfma_f32_16x16x32_bf16 v[248:251], a[152:155], v[92:95], v[248:251]
  v_mul_f32 v108, s27, v108
  v_cvt_pk_bf16_f32 v85, v106, v107
  v_mfma_f32_16x16x32_bf16 v[220:223], a[156:159], v[88:91], v[220:223]
  ds_read_b64_tr_b16 a[138:139], v22 offset:28672
  v_mul_f32 v109, s27, v109
  v_mfma_f32_16x16x32_bf16 v[252:255], a[156:159], v[92:95], v[252:255]
  buffer_load_dwordx4 v29, s[12:15], s22 offen offset:1024 nt lds
  v_mfma_f32_16x16x32_bf16 v[112:115], a[96:99], a[32:35], 0
  s_add_u32 s49, s49, 8192
  v_exp_f32 v108, v108
  v_mfma_f32_16x16x32_bf16 v[112:115], a[100:103], a[36:39], v[112:115]
  s_and_b32 s49, s49, 0xffff
  ds_read_b64_tr_b16 a[140:141], v23 offset:24576
  v_mul_f32 v110, s27, v110
  v_mfma_f32_16x16x32_bf16 v[112:115], a[104:107], a[40:43], v[112:115]
  s_add_u32 s56, s56, 2048
  v_exp_f32 v109, v109
  v_mfma_f32_16x16x32_bf16 v[112:115], a[108:111], a[44:47], v[112:115]
  s_and_b32 s56, s56, 32767
  ds_read_b64_tr_b16 a[142:143], v23 offset:28672
  v_cvt_pk_bf16_f32 v86, v108, v109
  v_mfma_f32_16x16x32_bf16 v[120:123], a[108:111], a[60:63], 0
  s_add_u32 s81, s81, 16777216
  v_exp_f32 v110, v110
  v_mul_f32 v111, s27, v111
  v_mfma_f32_16x16x32_bf16 v[120:123], a[104:107], a[56:59], v[120:123]
  s_add_u32 s22, s81, s56
  v_exp_f32 v111, v111
  v_mfma_f32_16x16x32_bf16 v[120:123], a[100:103], a[52:55], v[120:123]
  ds_read_b64_tr_b16 a[144:145], v24 offset:24576
  v_mul_f32 v100, s27, v100
  v_cvt_pk_bf16_f32 v87, v110, v111
  v_mfma_f32_16x16x32_bf16 v[120:123], a[96:99], a[48:51], v[120:123]
  v_exp_f32 v100, v100
  v_mfma_f32_16x16x32_bf16 v[124:127], a[112:115], a[48:51], 0
  ds_read_b64_tr_b16 a[146:147], v24 offset:28672
  v_mul_f32 v101, s27, v101
  v_mfma_f32_16x16x32_bf16 v[124:127], a[116:119], a[52:55], v[124:127]
  v_exp_f32 v101, v101
  v_mfma_f32_16x16x32_bf16 v[124:127], a[120:123], a[56:59], v[124:127]
  v_mul_f32 v102, s27, v102
  v_cvt_pk_bf16_f32 v82, v100, v101
  v_mfma_f32_16x16x32_bf16 v[124:127], a[124:127], a[60:63], v[124:127]
  ds_read_b64_tr_b16 a[148:149], v25 offset:24576
  v_mul_f32 v103, s27, v103
  v_mfma_f32_16x16x32_bf16 v[116:119], a[124:127], a[44:47], 0
  v_exp_f32 v102, v102
  v_mfma_f32_16x16x32_bf16 v[116:119], a[120:123], a[40:43], v[116:119]
  ds_read_b64_tr_b16 a[150:151], v25 offset:28672
  v_exp_f32 v103, v103
  v_mfma_f32_16x16x32_bf16 v[116:119], a[116:119], a[36:39], v[116:119]
  ds_read_b64_tr_b16 a[152:153], v26 offset:24576
  v_cvt_pk_bf16_f32 v83, v102, v103
  v_mfma_f32_16x16x32_bf16 v[116:119], a[112:115], a[32:35], v[116:119]
  s_waitcnt lgkmcnt(11)
  v_mul_f32 v112, s27, v112
  v_mul_f32 v113, s27, v113
  v_mfma_f32_16x16x32_bf16 v[128:131], a[128:131], v[80:83], v[128:131]
  s_add_u32 m0, s44, 6144
  v_exp_f32 v112, v112
  v_mfma_f32_16x16x32_bf16 v[160:163], a[128:131], v[84:87], v[160:163]
  s_waitcnt lgkmcnt(9)
  ds_read_b64_tr_b16 a[154:155], v26 offset:28672
  v_mul_f32 v114, s27, v114
  v_mfma_f32_16x16x32_bf16 v[132:135], a[132:135], v[80:83], v[132:135]
  buffer_load_dwordx4 v28, s[4:7], s67 offen offset:0 nt lds
  v_mfma_f32_16x16x32_bf16 v[164:167], a[132:135], v[84:87], v[164:167]
  s_waitcnt lgkmcnt(8)
  v_exp_f32 v113, v113
  v_mfma_f32_16x16x32_bf16 v[136:139], a[136:139], v[80:83], v[136:139]
  ds_read_b64_tr_b16 a[156:157], v27 offset:24576
  v_cvt_pk_bf16_f32 v88, v112, v113
  v_mfma_f32_16x16x32_bf16 v[168:171], a[136:139], v[84:87], v[168:171]
  v_exp_f32 v114, v114
  v_mfma_f32_16x16x32_bf16 a[224:227], a[240:243], v[80:83], a[224:227]
  s_waitcnt lgkmcnt(7)
  ds_read_b128 a[96:99], v16 offset:32768
  v_mul_f32 v115, s27, v115
  v_mfma_f32_16x16x32_bf16 v[140:143], a[140:143], v[80:83], v[140:143]
  ds_read_b64_tr_b16 a[158:159], v27 offset:28672
  v_exp_f32 v115, v115
  v_mfma_f32_16x16x32_bf16 v[172:175], a[140:143], v[84:87], v[172:175]
  s_waitcnt lgkmcnt(7)
  ds_read_b128 a[100:103], v17 offset:32768
  v_mul_f32 v120, s27, v120
  v_cvt_pk_bf16_f32 v89, v114, v115
  v_mfma_f32_16x16x32_bf16 v[144:147], a[144:147], v[80:83], v[144:147]
  v_exp_f32 v120, v120
  v_mfma_f32_16x16x32_bf16 v[176:179], a[144:147], v[84:87], v[176:179]
  s_waitcnt lgkmcnt(6)
  buffer_load_dwordx4 v29, s[4:7], s67 offen offset:1024 nt lds
  v_mfma_f32_16x16x32_bf16 v[148:151], a[148:151], v[80:83], v[148:151]
  ds_read_b128 a[104:107], v18 offset:32768
  ds_read_b128 a[108:111], v19 offset:32768
  v_mul_f32 v121, s27, v121
  v_mfma_f32_16x16x32_bf16 v[180:183], a[148:151], v[84:87], v[180:183]
  v_exp_f32 v121, v121
  v_mul_f32 v122, s27, v122
  v_mfma_f32_16x16x32_bf16 a[228:231], a[240:243], v[84:87], a[228:231]
  s_waitcnt lgkmcnt(6)
  v_cvt_pk_bf16_f32 v92, v120, v121
  v_mul_f32 v123, s27, v123
  v_exp_f32 v122, v122
  v_mfma_f32_16x16x32_bf16 v[152:155], a[152:155], v[80:83], v[152:155]
  v_exp_f32 v123, v123
  v_mfma_f32_16x16x32_bf16 v[184:187], a[152:155], v[84:87], v[184:187]
  s_waitcnt lgkmcnt(3)
  ds_read_b128 a[112:115], v16 offset:36864
  v_mul_f32 v124, s27, v124
  v_cvt_pk_bf16_f32 v93, v122, v123
  v_mfma_f32_16x16x32_bf16 v[156:159], a[156:159], v[80:83], v[156:159]
  v_exp_f32 v124, v124
  v_mul_f32 v125, s27, v125
  v_mfma_f32_16x16x32_bf16 v[188:191], a[156:159], v[84:87], v[188:191]
  ds_read_b128 a[116:119], v17 offset:36864
  v_exp_f32 v125, v125
  v_mfma_f32_16x16x32_bf16 v[96:99], a[96:99], a[0:3], 0
  s_waitcnt lgkmcnt(4)
  v_mul_f32 v126, s27, v126
  v_cvt_pk_bf16_f32 v94, v124, v125
  v_mfma_f32_16x16x32_bf16 v[96:99], a[100:103], a[4:7], v[96:99]
  s_waitcnt lgkmcnt(3)
  ds_read_b128 a[120:123], v18 offset:36864
  v_mul_f32 v127, s27, v127
  v_mfma_f32_16x16x32_bf16 v[96:99], a[104:107], a[8:11], v[96:99]
  s_waitcnt lgkmcnt(3)
  v_exp_f32 v126, v126
  v_mfma_f32_16x16x32_bf16 v[96:99], a[108:111], a[12:15], v[96:99]
  s_add_u32 s64, s64, 16777216
  v_exp_f32 v127, v127
  v_mfma_f32_16x16x32_bf16 v[104:107], a[108:111], a[28:31], 0
  s_add_u32 s65, s65, 16777216
  ds_read_b128 a[124:127], v19 offset:36864
  v_mul_f32 v116, s27, v116
  v_mfma_f32_16x16x32_bf16 v[104:107], a[104:107], a[24:27], v[104:107]
  s_add_u32 s66, s66, 16777216
  v_cvt_pk_bf16_f32 v95, v126, v127
  v_mul_f32 v117, s27, v117
  v_mfma_f32_16x16x32_bf16 v[104:107], a[100:103], a[20:23], v[104:107]
  s_add_u32 s67, s67, 16777216
  v_exp_f32 v116, v116
  v_mfma_f32_16x16x32_bf16 v[104:107], a[96:99], a[16:19], v[104:107]
  s_waitcnt lgkmcnt(3)
  v_exp_f32 v117, v117
  v_mfma_f32_16x16x32_bf16 v[108:111], a[112:115], a[16:19], 0
  s_waitcnt lgkmcnt(2)
  v_mul_f32 v118, s27, v118
  v_cvt_pk_bf16_f32 v90, v116, v117
  v_mfma_f32_16x16x32_bf16 v[108:111], a[116:119], a[20:23], v[108:111]
  s_waitcnt lgkmcnt(1)
  v_exp_f32 v118, v118
  v_mfma_f32_16x16x32_bf16 v[108:111], a[120:123], a[24:27], v[108:111]
  s_waitcnt lgkmcnt(0)
  v_mul_f32 v119, s27, v119
  v_mul_f32 v96, s27, v96
  v_mfma_f32_16x16x32_bf16 v[108:111], a[124:127], a[28:31], v[108:111]
  s_add_u32 s68, s68, 16777216
  v_exp_f32 v119, v119
  v_mfma_f32_16x16x32_bf16 v[100:103], a[124:127], a[12:15], 0
  s_add_u32 s69, s69, 16777216
  v_cvt_pk_bf16_f32 v91, v118, v119
  v_mul_f32 v97, s27, v97
  v_mfma_f32_16x16x32_bf16 v[100:103], a[120:123], a[8:11], v[100:103]
  s_waitcnt vmcnt(14)
  v_exp_f32 v96, v96
  v_mfma_f32_16x16x32_bf16 v[100:103], a[116:119], a[4:7], v[100:103]
  s_barrier
  v_exp_f32 v97, v97
  v_mfma_f32_16x16x32_bf16 v[100:103], a[112:115], a[0:3], v[100:103]
  s_add_u32 s70, s70, 16777216
  v_mul_f32 v98, s27, v98
  v_cvt_pk_bf16_f32 v80, v96, v97
  v_mfma_f32_16x16x32_bf16 v[192:195], a[128:131], v[88:91], v[192:195]
  s_add_u32 s71, s71, 16777216
  s_add_u32 m0, s29, 0
  v_exp_f32 v98, v98
  v_mfma_f32_16x16x32_bf16 v[224:227], a[128:131], v[92:95], v[224:227]
  buffer_load_dwordx4 v28, s[8:11], s21 offen offset:0 nt lds
  v_mfma_f32_16x16x32_bf16 v[196:199], a[132:135], v[88:91], v[196:199]
  ds_read_b64_tr_b16 a[128:129], v20 offset:32768
  v_mul_f32 v99, s27, v99
  v_mfma_f32_16x16x32_bf16 v[228:231], a[132:135], v[92:95], v[228:231]
  ds_read_b64_tr_b16 a[130:131], v20 offset:36864
  v_mul_f32 v104, s27, v104
  v_mfma_f32_16x16x32_bf16 v[200:203], a[136:139], v[88:91], v[200:203]
  v_exp_f32 v99, v99
  v_mfma_f32_16x16x32_bf16 v[232:235], a[136:139], v[92:95], v[232:235]
  ds_read_b64_tr_b16 a[132:133], v21 offset:32768
  v_cvt_pk_bf16_f32 v81, v98, v99
  v_mfma_f32_16x16x32_bf16 a[232:235], a[240:243], v[88:91], a[232:235]
  v_exp_f32 v104, v104
  v_mfma_f32_16x16x32_bf16 v[204:207], a[140:143], v[88:91], v[204:207]
  ds_read_b64_tr_b16 a[134:135], v21 offset:36864
  v_mul_f32 v105, s27, v105
  v_mfma_f32_16x16x32_bf16 v[236:239], a[140:143], v[92:95], v[236:239]
  v_exp_f32 v105, v105
  v_mfma_f32_16x16x32_bf16 v[208:211], a[144:147], v[88:91], v[208:211]
  buffer_load_dwordx4 v29, s[8:11], s21 offen offset:1024 nt lds
  v_mfma_f32_16x16x32_bf16 v[240:243], a[144:147], v[92:95], v[240:243]
  s_add_u32 s29, s29, 8192
  v_mul_f32 v106, s27, v106
  v_cvt_pk_bf16_f32 v84, v104, v105
  v_mfma_f32_16x16x32_bf16 v[212:215], a[148:151], v[88:91], v[212:215]
  s_and_b32 s29, s29, 0xffff
  v_exp_f32 v106, v106
  v_mfma_f32_16x16x32_bf16 v[244:247], a[148:151], v[92:95], v[244:247]
  s_add_u32 s55, s55, 2048
  ds_read_b64_tr_b16 a[136:137], v22 offset:32768
  v_mul_f32 v107, s27, v107
  v_mfma_f32_16x16x32_bf16 a[236:239], a[240:243], v[92:95], a[236:239]
  s_and_b32 s55, s55, 32767
  v_exp_f32 v107, v107
  v_mfma_f32_16x16x32_bf16 v[216:219], a[152:155], v[88:91], v[216:219]
  s_add_u32 s21, s80, s55
  v_mul_f32 v108, s27, v108
  v_cvt_pk_bf16_f32 v85, v106, v107
  v_mfma_f32_16x16x32_bf16 v[248:251], a[152:155], v[92:95], v[248:251]
  ds_read_b64_tr_b16 a[138:139], v22 offset:36864
  v_mul_f32 v109, s27, v109
  v_mfma_f32_16x16x32_bf16 v[220:223], a[156:159], v[88:91], v[220:223]
  s_add_u32 m0, s49, 65536
  v_exp_f32 v108, v108
  v_mfma_f32_16x16x32_bf16 v[252:255], a[156:159], v[92:95], v[252:255]
  buffer_load_dwordx4 v28, s[12:15], s22 offen offset:0 nt lds
  v_mfma_f32_16x16x32_bf16 v[112:115], a[96:99], a[32:35], 0
  ds_read_b64_tr_b16 a[140:141], v23 offset:32768
  v_mul_f32 v110, s27, v110
  v_mfma_f32_16x16x32_bf16 v[112:115], a[100:103], a[36:39], v[112:115]
  v_exp_f32 v109, v109
  v_mfma_f32_16x16x32_bf16 v[112:115], a[104:107], a[40:43], v[112:115]
  ds_read_b64_tr_b16 a[142:143], v23 offset:36864
  v_cvt_pk_bf16_f32 v86, v108, v109
  v_mfma_f32_16x16x32_bf16 v[112:115], a[108:111], a[44:47], v[112:115]
  v_exp_f32 v110, v110
  v_mfma_f32_16x16x32_bf16 v[120:123], a[108:111], a[60:63], 0
  ds_read_b64_tr_b16 a[144:145], v24 offset:32768
  v_mul_f32 v111, s27, v111
  v_mfma_f32_16x16x32_bf16 v[120:123], a[104:107], a[56:59], v[120:123]
  v_exp_f32 v111, v111
  v_mfma_f32_16x16x32_bf16 v[120:123], a[100:103], a[52:55], v[120:123]
  v_mul_f32 v100, s27, v100
  v_cvt_pk_bf16_f32 v87, v110, v111
  v_mfma_f32_16x16x32_bf16 v[120:123], a[96:99], a[48:51], v[120:123]
  buffer_load_dwordx4 v29, s[12:15], s22 offen offset:1024 nt lds
  v_mfma_f32_16x16x32_bf16 v[124:127], a[112:115], a[48:51], 0
  s_add_u32 s49, s49, 8192
  v_exp_f32 v100, v100
  v_mul_f32 v101, s27, v101
  v_mfma_f32_16x16x32_bf16 v[124:127], a[116:119], a[52:55], v[124:127]
  s_and_b32 s49, s49, 0xffff
  ds_read_b64_tr_b16 a[146:147], v24 offset:36864
  v_mul_f32 v102, s27, v102
  v_mfma_f32_16x16x32_bf16 v[124:127], a[120:123], a[56:59], v[124:127]
  s_add_u32 s56, s56, 2048
  v_exp_f32 v101, v101
  v_mfma_f32_16x16x32_bf16 v[124:127], a[124:127], a[60:63], v[124:127]
  s_and_b32 s56, s56, 32767
  ds_read_b64_tr_b16 a[148:149], v25 offset:32768
  v_cvt_pk_bf16_f32 v82, v100, v101
  v_mfma_f32_16x16x32_bf16 v[116:119], a[124:127], a[44:47], 0
  s_add_u32 s22, s81, s56
  ds_read_b64_tr_b16 a[150:151], v25 offset:36864
  v_mul_f32 v103, s27, v103
  v_exp_f32 v102, v102
  v_mfma_f32_16x16x32_bf16 v[116:119], a[120:123], a[40:43], v[116:119]
  v_exp_f32 v103, v103
  v_mfma_f32_16x16x32_bf16 v[116:119], a[116:119], a[36:39], v[116:119]
  ds_read_b64_tr_b16 a[152:153], v26 offset:32768
  v_cvt_pk_bf16_f32 v83, v102, v103
  v_mfma_f32_16x16x32_bf16 v[116:119], a[112:115], a[32:35], v[116:119]
  s_waitcnt lgkmcnt(11)
  v_mul_f32 v112, s27, v112
  v_mul_f32 v113, s27, v113
  v_mfma_f32_16x16x32_bf16 v[128:131], a[128:131], v[80:83], v[128:131]
  v_exp_f32 v112, v112
  v_mfma_f32_16x16x32_bf16 v[160:163], a[128:131], v[84:87], v[160:163]
  s_waitcnt lgkmcnt(9)
  ds_read_b64_tr_b16 a[154:155], v26 offset:36864
  v_mul_f32 v114, s27, v114
  v_mfma_f32_16x16x32_bf16 v[132:135], a[132:135], v[80:83], v[132:135]
  buffer_store_dwordx4 a[192:195], v40, s[16:19], s76 offen offset:0 nt
  ds_read_b64_tr_b16 a[156:157], v27 offset:32768
  v_exp_f32 v113, v113
  v_mfma_f32_16x16x32_bf16 v[164:167], a[132:135], v[84:87], v[164:167]
  s_waitcnt lgkmcnt(9)
  ds_read_b128 a[96:99], v16 offset:40960
  v_cvt_pk_bf16_f32 v88, v112, v113
  v_mfma_f32_16x16x32_bf16 v[136:139], a[136:139], v[80:83], v[136:139]
  v_exp_f32 v114, v114
  v_mfma_f32_16x16x32_bf16 v[168:171], a[136:139], v[84:87], v[168:171]
  ds_read_b64_tr_b16 a[158:159], v27 offset:36864
  v_mul_f32 v115, s27, v115
  v_mfma_f32_16x16x32_bf16 a[224:227], a[240:243], v[80:83], a[224:227]
  s_waitcnt lgkmcnt(9)
  v_exp_f32 v115, v115
  v_mfma_f32_16x16x32_bf16 v[140:143], a[140:143], v[80:83], v[140:143]
  v_mul_f32 v120, s27, v120
  v_cvt_pk_bf16_f32 v89, v114, v115
  v_mfma_f32_16x16x32_bf16 v[172:175], a[140:143], v[84:87], v[172:175]
  s_waitcnt lgkmcnt(7)
  ds_read_b128 a[100:103], v17 offset:40960
  v_mul_f32 v121, s27, v121
  v_mfma_f32_16x16x32_bf16 v[144:147], a[144:147], v[80:83], v[144:147]
  v_exp_f32 v120, v120
  v_mfma_f32_16x16x32_bf16 v[176:179], a[144:147], v[84:87], v[176:179]
  s_waitcnt lgkmcnt(6)
  buffer_store_dwordx4 a[196:199], v40, s[16:19], s76 offen offset:1024 nt
  ds_read_b128 a[104:107], v18 offset:40960
  v_exp_f32 v121, v121
  v_mfma_f32_16x16x32_bf16 v[148:151], a[148:151], v[80:83], v[148:151]
  v_mul_f32 v122, s27, v122
  v_cvt_pk_bf16_f32 v92, v120, v121
  v_mfma_f32_16x16x32_bf16 v[180:183], a[148:151], v[84:87], v[180:183]
  v_exp_f32 v122, v122
  v_mfma_f32_16x16x32_bf16 a[228:231], a[240:243], v[84:87], a[228:231]
  s_waitcnt lgkmcnt(5)
  ds_read_b128 a[108:111], v19 offset:40960
  v_mul_f32 v123, s27, v123
  v_mfma_f32_16x16x32_bf16 v[152:155], a[152:155], v[80:83], v[152:155]
  v_exp_f32 v123, v123
  v_mfma_f32_16x16x32_bf16 v[184:187], a[152:155], v[84:87], v[184:187]
  s_waitcnt lgkmcnt(3)
  ds_read_b128 a[112:115], v16 offset:45056
  v_mul_f32 v124, s27, v124
  v_cvt_pk_bf16_f32 v93, v122, v123
  v_mfma_f32_16x16x32_bf16 v[156:159], a[156:159], v[80:83], v[156:159]
  v_exp_f32 v124, v124
  v_mul_f32 v125, s27, v125
  v_mfma_f32_16x16x32_bf16 v[188:191], a[156:159], v[84:87], v[188:191]
  ds_read_b128 a[116:119], v17 offset:45056
  v_exp_f32 v125, v125
  v_mfma_f32_16x16x32_bf16 v[96:99], a[96:99], a[0:3], 0
  s_waitcnt lgkmcnt(4)
  v_mul_f32 v126, s27, v126
  v_cvt_pk_bf16_f32 v94, v124, v125
  v_mfma_f32_16x16x32_bf16 v[96:99], a[100:103], a[4:7], v[96:99]
  s_waitcnt lgkmcnt(3)
  ds_read_b128 a[120:123], v18 offset:45056
  v_mul_f32 v127, s27, v127
  v_mfma_f32_16x16x32_bf16 v[96:99], a[104:107], a[8:11], v[96:99]
  s_waitcnt lgkmcnt(3)
  v_exp_f32 v126, v126
  v_mfma_f32_16x16x32_bf16 v[96:99], a[108:111], a[12:15], v[96:99]
  v_exp_f32 v127, v127
  v_mfma_f32_16x16x32_bf16 v[104:107], a[108:111], a[28:31], 0
  ds_read_b128 a[124:127], v19 offset:45056
  v_mul_f32 v116, s27, v116
  v_mfma_f32_16x16x32_bf16 v[104:107], a[104:107], a[24:27], v[104:107]
  v_cvt_pk_bf16_f32 v95, v126, v127
  v_mul_f32 v117, s27, v117
  v_mfma_f32_16x16x32_bf16 v[104:107], a[100:103], a[20:23], v[104:107]
  s_add_u32 m0, s29, 0
  v_exp_f32 v116, v116
  v_mfma_f32_16x16x32_bf16 v[104:107], a[96:99], a[16:19], v[104:107]
  s_waitcnt lgkmcnt(3)
  v_exp_f32 v117, v117
  v_mfma_f32_16x16x32_bf16 v[108:111], a[112:115], a[16:19], 0
  s_waitcnt lgkmcnt(2)
  v_mul_f32 v118, s27, v118
  v_cvt_pk_bf16_f32 v90, v116, v117
  v_mfma_f32_16x16x32_bf16 v[108:111], a[116:119], a[20:23], v[108:111]
  s_waitcnt lgkmcnt(1)
  buffer_load_dwordx4 v28, s[8:11], s21 offen offset:0 nt lds
  v_mfma_f32_16x16x32_bf16 v[108:111], a[120:123], a[24:27], v[108:111]
  s_waitcnt lgkmcnt(0)
  v_exp_f32 v118, v118
  v_mfma_f32_16x16x32_bf16 v[108:111], a[124:127], a[28:31], v[108:111]
  v_mul_f32 v119, s27, v119
  v_mul_f32 v96, s27, v96
  v_mfma_f32_16x16x32_bf16 v[100:103], a[124:127], a[12:15], 0
  v_exp_f32 v119, v119
  v_mfma_f32_16x16x32_bf16 v[100:103], a[120:123], a[8:11], v[100:103]
  v_cvt_pk_bf16_f32 v91, v118, v119
  v_mul_f32 v97, s27, v97
  v_mfma_f32_16x16x32_bf16 v[100:103], a[116:119], a[4:7], v[100:103]
  v_exp_f32 v96, v96
  v_mfma_f32_16x16x32_bf16 v[100:103], a[112:115], a[0:3], v[100:103]
  v_exp_f32 v97, v97
  v_mfma_f32_16x16x32_bf16 v[192:195], a[128:131], v[88:91], v[192:195]
  v_mul_f32 v98, s27, v98
  v_cvt_pk_bf16_f32 v80, v96, v97
  v_mfma_f32_16x16x32_bf16 v[224:227], a[128:131], v[92:95], v[224:227]
  buffer_load_dwordx4 v29, s[8:11], s21 offen offset:1024 nt lds
  v_mfma_f32_16x16x32_bf16 v[196:199], a[132:135], v[88:91], v[196:199]
  s_add_u32 s29, s29, 8192
  ds_read_b64_tr_b16 a[128:129], v20 offset:40960
  v_mul_f32 v99, s27, v99
  v_mfma_f32_16x16x32_bf16 v[228:231], a[132:135], v[92:95], v[228:231]
  s_and_b32 s29, s29, 0xffff
  v_exp_f32 v98, v98
  v_mfma_f32_16x16x32_bf16 v[200:203], a[136:139], v[88:91], v[200:203]
  s_add_u32 s55, s55, 2048
  ds_read_b64_tr_b16 a[130:131], v20 offset:45056
  v_mul_f32 v104, s27, v104
  v_mfma_f32_16x16x32_bf16 v[232:235], a[136:139], v[92:95], v[232:235]
  s_and_b32 s55, s55, 32767
  v_exp_f32 v99, v99
  v_mfma_f32_16x16x32_bf16 a[232:235], a[240:243], v[88:91], a[232:235]
  s_add_u32 s21, s80, s55
  ds_read_b64_tr_b16 a[132:133], v21 offset:40960
  v_cvt_pk_bf16_f32 v81, v98, v99
  v_mfma_f32_16x16x32_bf16 v[204:207], a[140:143], v[88:91], v[204:207]
  v_exp_f32 v104, v104
  v_mfma_f32_16x16x32_bf16 v[236:239], a[140:143], v[92:95], v[236:239]
  s_add_u32 m0, s49, 65536
  ds_read_b64_tr_b16 a[134:135], v21 offset:45056
  v_mul_f32 v105, s27, v105
  v_mfma_f32_16x16x32_bf16 v[208:211], a[144:147], v[88:91], v[208:211]
  buffer_load_dwordx4 v28, s[12:15], s22 offen offset:0 nt lds
  v_mfma_f32_16x16x32_bf16 v[240:243], a[144:147], v[92:95], v[240:243]
  v_exp_f32 v105, v105
  v_mfma_f32_16x16x32_bf16 v[212:215], a[148:151], v[88:91], v[212:215]
  v_mul_f32 v106, s27, v106
  v_cvt_pk_bf16_f32 v84, v104, v105
  v_mfma_f32_16x16x32_bf16 v[244:247], a[148:151], v[92:95], v[244:247]
  v_exp_f32 v106, v106
  v_mfma_f32_16x16x32_bf16 a[236:239], a[240:243], v[92:95], a[236:239]
  ds_read_b64_tr_b16 a[136:137], v22 offset:40960
  v_mul_f32 v107, s27, v107
  v_mfma_f32_16x16x32_bf16 v[216:219], a[152:155], v[88:91], v[216:219]
  v_exp_f32 v107, v107
  v_mfma_f32_16x16x32_bf16 v[248:251], a[152:155], v[92:95], v[248:251]
  v_mul_f32 v108, s27, v108
  v_cvt_pk_bf16_f32 v85, v106, v107
  v_mfma_f32_16x16x32_bf16 v[220:223], a[156:159], v[88:91], v[220:223]
  ds_read_b64_tr_b16 a[138:139], v22 offset:45056
  v_mul_f32 v109, s27, v109
  v_mfma_f32_16x16x32_bf16 v[252:255], a[156:159], v[92:95], v[252:255]
  buffer_load_dwordx4 v29, s[12:15], s22 offen offset:1024 nt lds
  v_mfma_f32_16x16x32_bf16 v[112:115], a[96:99], a[32:35], 0
  s_add_u32 s49, s49, 8192
  v_exp_f32 v108, v108
  v_mfma_f32_16x16x32_bf16 v[112:115], a[100:103], a[36:39], v[112:115]
  s_and_b32 s49, s49, 0xffff
  ds_read_b64_tr_b16 a[140:141], v23 offset:40960
  v_mul_f32 v110, s27, v110
  v_mfma_f32_16x16x32_bf16 v[112:115], a[104:107], a[40:43], v[112:115]
  s_add_u32 s56, s56, 2048
  v_exp_f32 v109, v109
  v_mfma_f32_16x16x32_bf16 v[112:115], a[108:111], a[44:47], v[112:115]
  s_and_b32 s56, s56, 32767
  ds_read_b64_tr_b16 a[142:143], v23 offset:45056
  v_cvt_pk_bf16_f32 v86, v108, v109
  v_mfma_f32_16x16x32_bf16 v[120:123], a[108:111], a[60:63], 0
  s_add_u32 s22, s81, s56
  v_exp_f32 v110, v110
  v_mul_f32 v111, s27, v111
  v_mfma_f32_16x16x32_bf16 v[120:123], a[104:107], a[56:59], v[120:123]
  v_exp_f32 v111, v111
  v_mfma_f32_16x16x32_bf16 v[120:123], a[100:103], a[52:55], v[120:123]
  ds_read_b64_tr_b16 a[144:145], v24 offset:40960
  v_mul_f32 v100, s27, v100
  v_cvt_pk_bf16_f32 v87, v110, v111
  v_mfma_f32_16x16x32_bf16 v[120:123], a[96:99], a[48:51], v[120:123]
  v_exp_f32 v100, v100
  v_mfma_f32_16x16x32_bf16 v[124:127], a[112:115], a[48:51], 0
  ds_read_b64_tr_b16 a[146:147], v24 offset:45056
  v_mul_f32 v101, s27, v101
  v_mfma_f32_16x16x32_bf16 v[124:127], a[116:119], a[52:55], v[124:127]
  v_exp_f32 v101, v101
  v_mfma_f32_16x16x32_bf16 v[124:127], a[120:123], a[56:59], v[124:127]
  v_mul_f32 v102, s27, v102
  v_cvt_pk_bf16_f32 v82, v100, v101
  v_mfma_f32_16x16x32_bf16 v[124:127], a[124:127], a[60:63], v[124:127]
  ds_read_b64_tr_b16 a[148:149], v25 offset:40960
  v_mul_f32 v103, s27, v103
  v_mfma_f32_16x16x32_bf16 v[116:119], a[124:127], a[44:47], 0
  v_exp_f32 v102, v102
  v_mfma_f32_16x16x32_bf16 v[116:119], a[120:123], a[40:43], v[116:119]
  ds_read_b64_tr_b16 a[150:151], v25 offset:45056
  v_exp_f32 v103, v103
  v_mfma_f32_16x16x32_bf16 v[116:119], a[116:119], a[36:39], v[116:119]
  ds_read_b64_tr_b16 a[152:153], v26 offset:40960
  v_cvt_pk_bf16_f32 v83, v102, v103
  v_mfma_f32_16x16x32_bf16 v[116:119], a[112:115], a[32:35], v[116:119]
  s_waitcnt lgkmcnt(11)
  v_mul_f32 v112, s27, v112
  v_mul_f32 v113, s27, v113
  v_mfma_f32_16x16x32_bf16 v[128:131], a[128:131], v[80:83], v[128:131]
  v_exp_f32 v112, v112
  v_mfma_f32_16x16x32_bf16 v[160:163], a[128:131], v[84:87], v[160:163]
  s_waitcnt lgkmcnt(9)
  ds_read_b64_tr_b16 a[154:155], v26 offset:45056
  v_mul_f32 v114, s27, v114
  v_mfma_f32_16x16x32_bf16 v[132:135], a[132:135], v[80:83], v[132:135]
  buffer_store_dwordx4 a[200:203], v40, s[16:19], s77 offen offset:0 nt
  ds_read_b64_tr_b16 a[156:157], v27 offset:40960
  v_exp_f32 v113, v113
  v_mfma_f32_16x16x32_bf16 v[164:167], a[132:135], v[84:87], v[164:167]
  s_waitcnt lgkmcnt(9)
  ds_read_b128 a[96:99], v16 offset:49152
  v_cvt_pk_bf16_f32 v88, v112, v113
  v_mfma_f32_16x16x32_bf16 v[136:139], a[136:139], v[80:83], v[136:139]
  v_exp_f32 v114, v114
  v_mfma_f32_16x16x32_bf16 v[168:171], a[136:139], v[84:87], v[168:171]
  ds_read_b64_tr_b16 a[158:159], v27 offset:45056
  v_mul_f32 v115, s27, v115
  v_mfma_f32_16x16x32_bf16 a[224:227], a[240:243], v[80:83], a[224:227]
  s_waitcnt lgkmcnt(9)
  v_exp_f32 v115, v115
  v_mfma_f32_16x16x32_bf16 v[140:143], a[140:143], v[80:83], v[140:143]
  v_mul_f32 v120, s27, v120
  v_cvt_pk_bf16_f32 v89, v114, v115
  v_mfma_f32_16x16x32_bf16 v[172:175], a[140:143], v[84:87], v[172:175]
  s_waitcnt lgkmcnt(7)
  ds_read_b128 a[100:103], v17 offset:49152
  v_mul_f32 v121, s27, v121
  v_mfma_f32_16x16x32_bf16 v[144:147], a[144:147], v[80:83], v[144:147]
  v_exp_f32 v120, v120
  v_mfma_f32_16x16x32_bf16 v[176:179], a[144:147], v[84:87], v[176:179]
  s_waitcnt lgkmcnt(6)
  buffer_store_dwordx4 a[204:207], v40, s[16:19], s77 offen offset:1024 nt
  ds_read_b128 a[104:107], v18 offset:49152
  v_exp_f32 v121, v121
  v_mfma_f32_16x16x32_bf16 v[148:151], a[148:151], v[80:83], v[148:151]
  v_mul_f32 v122, s27, v122
  v_cvt_pk_bf16_f32 v92, v120, v121
  v_mfma_f32_16x16x32_bf16 v[180:183], a[148:151], v[84:87], v[180:183]
  v_exp_f32 v122, v122
  v_mfma_f32_16x16x32_bf16 a[228:231], a[240:243], v[84:87], a[228:231]
  s_waitcnt lgkmcnt(5)
  ds_read_b128 a[108:111], v19 offset:49152
  v_mul_f32 v123, s27, v123
  v_mfma_f32_16x16x32_bf16 v[152:155], a[152:155], v[80:83], v[152:155]
  v_exp_f32 v123, v123
  v_mfma_f32_16x16x32_bf16 v[184:187], a[152:155], v[84:87], v[184:187]
  s_waitcnt lgkmcnt(3)
  ds_read_b128 a[112:115], v16 offset:53248
  v_mul_f32 v124, s27, v124
  v_cvt_pk_bf16_f32 v93, v122, v123
  v_mfma_f32_16x16x32_bf16 v[156:159], a[156:159], v[80:83], v[156:159]
  v_exp_f32 v124, v124
  v_mul_f32 v125, s27, v125
  v_mfma_f32_16x16x32_bf16 v[188:191], a[156:159], v[84:87], v[188:191]
  ds_read_b128 a[116:119], v17 offset:53248
  v_exp_f32 v125, v125
  v_mfma_f32_16x16x32_bf16 v[96:99], a[96:99], a[0:3], 0
  s_waitcnt lgkmcnt(4)
  v_mul_f32 v126, s27, v126
  v_cvt_pk_bf16_f32 v94, v124, v125
  v_mfma_f32_16x16x32_bf16 v[96:99], a[100:103], a[4:7], v[96:99]
  s_waitcnt lgkmcnt(3)
  ds_read_b128 a[120:123], v18 offset:53248
  v_mul_f32 v127, s27, v127
  v_mfma_f32_16x16x32_bf16 v[96:99], a[104:107], a[8:11], v[96:99]
  s_waitcnt lgkmcnt(3)
  v_exp_f32 v126, v126
  v_mfma_f32_16x16x32_bf16 v[96:99], a[108:111], a[12:15], v[96:99]
  v_exp_f32 v127, v127
  v_mfma_f32_16x16x32_bf16 v[104:107], a[108:111], a[28:31], 0
  ds_read_b128 a[124:127], v19 offset:53248
  v_mul_f32 v116, s27, v116
  v_mfma_f32_16x16x32_bf16 v[104:107], a[104:107], a[24:27], v[104:107]
  v_cvt_pk_bf16_f32 v95, v126, v127
  v_mul_f32 v117, s27, v117
  v_mfma_f32_16x16x32_bf16 v[104:107], a[100:103], a[20:23], v[104:107]
  v_exp_f32 v116, v116
  v_mfma_f32_16x16x32_bf16 v[104:107], a[96:99], a[16:19], v[104:107]
  s_waitcnt lgkmcnt(3)
  v_exp_f32 v117, v117
  v_mfma_f32_16x16x32_bf16 v[108:111], a[112:115], a[16:19], 0
  s_waitcnt lgkmcnt(2)
  v_mul_f32 v118, s27, v118
  v_cvt_pk_bf16_f32 v90, v116, v117
  v_mfma_f32_16x16x32_bf16 v[108:111], a[116:119], a[20:23], v[108:111]
  s_waitcnt lgkmcnt(1)
  v_exp_f32 v118, v118
  v_mfma_f32_16x16x32_bf16 v[108:111], a[120:123], a[24:27], v[108:111]
  s_waitcnt lgkmcnt(0)
  v_mul_f32 v119, s27, v119
  v_mul_f32 v96, s27, v96
  v_mfma_f32_16x16x32_bf16 v[108:111], a[124:127], a[28:31], v[108:111]
  v_exp_f32 v119, v119
  v_mfma_f32_16x16x32_bf16 v[100:103], a[124:127], a[12:15], 0
  v_cvt_pk_bf16_f32 v91, v118, v119
  v_mul_f32 v97, s27, v97
  v_mfma_f32_16x16x32_bf16 v[100:103], a[120:123], a[8:11], v[100:103]
  s_waitcnt vmcnt(14)
  v_exp_f32 v96, v96
  v_mfma_f32_16x16x32_bf16 v[100:103], a[116:119], a[4:7], v[100:103]
  s_barrier
  v_exp_f32 v97, v97
  v_mfma_f32_16x16x32_bf16 v[100:103], a[112:115], a[0:3], v[100:103]
  v_mul_f32 v98, s27, v98
  v_cvt_pk_bf16_f32 v80, v96, v97
  v_mfma_f32_16x16x32_bf16 v[192:195], a[128:131], v[88:91], v[192:195]
  s_add_u32 m0, s29, 0
  v_exp_f32 v98, v98
  v_mfma_f32_16x16x32_bf16 v[224:227], a[128:131], v[92:95], v[224:227]
  buffer_load_dwordx4 v28, s[8:11], s21 offen offset:0 nt lds
  v_mfma_f32_16x16x32_bf16 v[196:199], a[132:135], v[88:91], v[196:199]
  ds_read_b64_tr_b16 a[128:129], v20 offset:49152
  v_mul_f32 v99, s27, v99
  v_mfma_f32_16x16x32_bf16 v[228:231], a[132:135], v[92:95], v[228:231]
  ds_read_b64_tr_b16 a[130:131], v20 offset:53248
  v_mul_f32 v104, s27, v104
  v_mfma_f32_16x16x32_bf16 v[200:203], a[136:139], v[88:91], v[200:203]
  v_exp_f32 v99, v99
  v_mfma_f32_16x16x32_bf16 v[232:235], a[136:139], v[92:95], v[232:235]
  ds_read_b64_tr_b16 a[132:133], v21 offset:49152
  v_cvt_pk_bf16_f32 v81, v98, v99
  v_mfma_f32_16x16x32_bf16 a[232:235], a[240:243], v[88:91], a[232:235]
  v_exp_f32 v104, v104
  v_mfma_f32_16x16x32_bf16 v[204:207], a[140:143], v[88:91], v[204:207]
  ds_read_b64_tr_b16 a[134:135], v21 offset:53248
  v_mul_f32 v105, s27, v105
  v_mfma_f32_16x16x32_bf16 v[236:239], a[140:143], v[92:95], v[236:239]
  v_exp_f32 v105, v105
  v_mfma_f32_16x16x32_bf16 v[208:211], a[144:147], v[88:91], v[208:211]
  buffer_load_dwordx4 v29, s[8:11], s21 offen offset:1024 nt lds
  v_mfma_f32_16x16x32_bf16 v[240:243], a[144:147], v[92:95], v[240:243]
  s_add_u32 s29, s29, 8192
  v_mul_f32 v106, s27, v106
  v_cvt_pk_bf16_f32 v84, v104, v105
  v_mfma_f32_16x16x32_bf16 v[212:215], a[148:151], v[88:91], v[212:215]
  s_and_b32 s29, s29, 0xffff
  v_exp_f32 v106, v106
  v_mfma_f32_16x16x32_bf16 v[244:247], a[148:151], v[92:95], v[244:247]
  s_add_u32 s55, s55, 2048
  ds_read_b64_tr_b16 a[136:137], v22 offset:49152
  v_mul_f32 v107, s27, v107
  v_mfma_f32_16x16x32_bf16 a[236:239], a[240:243], v[92:95], a[236:239]
  s_and_b32 s55, s55, 32767
  v_exp_f32 v107, v107
  v_mfma_f32_16x16x32_bf16 v[216:219], a[152:155], v[88:91], v[216:219]
  s_add_u32 s21, s80, s55
  v_mul_f32 v108, s27, v108
  v_cvt_pk_bf16_f32 v85, v106, v107
  v_mfma_f32_16x16x32_bf16 v[248:251], a[152:155], v[92:95], v[248:251]
  ds_read_b64_tr_b16 a[138:139], v22 offset:53248
  v_mul_f32 v109, s27, v109
  v_mfma_f32_16x16x32_bf16 v[220:223], a[156:159], v[88:91], v[220:223]
  s_add_u32 m0, s49, 65536
  v_exp_f32 v108, v108
  v_mfma_f32_16x16x32_bf16 v[252:255], a[156:159], v[92:95], v[252:255]
  buffer_load_dwordx4 v28, s[12:15], s22 offen offset:0 nt lds
  v_mfma_f32_16x16x32_bf16 v[112:115], a[96:99], a[32:35], 0
  ds_read_b64_tr_b16 a[140:141], v23 offset:49152
  v_mul_f32 v110, s27, v110
  v_mfma_f32_16x16x32_bf16 v[112:115], a[100:103], a[36:39], v[112:115]
  v_exp_f32 v109, v109
  v_mfma_f32_16x16x32_bf16 v[112:115], a[104:107], a[40:43], v[112:115]
  ds_read_b64_tr_b16 a[142:143], v23 offset:53248
  v_cvt_pk_bf16_f32 v86, v108, v109
  v_mfma_f32_16x16x32_bf16 v[112:115], a[108:111], a[44:47], v[112:115]
  v_exp_f32 v110, v110
  v_mfma_f32_16x16x32_bf16 v[120:123], a[108:111], a[60:63], 0
  ds_read_b64_tr_b16 a[144:145], v24 offset:49152
  v_mul_f32 v111, s27, v111
  v_mfma_f32_16x16x32_bf16 v[120:123], a[104:107], a[56:59], v[120:123]
  v_exp_f32 v111, v111
  v_mfma_f32_16x16x32_bf16 v[120:123], a[100:103], a[52:55], v[120:123]
  v_mul_f32 v100, s27, v100
  v_cvt_pk_bf16_f32 v87, v110, v111
  v_mfma_f32_16x16x32_bf16 v[120:123], a[96:99], a[48:51], v[120:123]
  buffer_load_dwordx4 v29, s[12:15], s22 offen offset:1024 nt lds
  v_mfma_f32_16x16x32_bf16 v[124:127], a[112:115], a[48:51], 0
  s_add_u32 s49, s49, 8192
  v_exp_f32 v100, v100
  v_mul_f32 v101, s27, v101
  v_mfma_f32_16x16x32_bf16 v[124:127], a[116:119], a[52:55], v[124:127]
  s_and_b32 s49, s49, 0xffff
  ds_read_b64_tr_b16 a[146:147], v24 offset:53248
  v_mul_f32 v102, s27, v102
  v_mfma_f32_16x16x32_bf16 v[124:127], a[120:123], a[56:59], v[124:127]
  s_add_u32 s56, s56, 2048
  v_exp_f32 v101, v101
  v_mfma_f32_16x16x32_bf16 v[124:127], a[124:127], a[60:63], v[124:127]
  s_and_b32 s56, s56, 32767
  ds_read_b64_tr_b16 a[148:149], v25 offset:49152
  v_cvt_pk_bf16_f32 v82, v100, v101
  v_mfma_f32_16x16x32_bf16 v[116:119], a[124:127], a[44:47], 0
  s_add_u32 s22, s81, s56
  ds_read_b64_tr_b16 a[150:151], v25 offset:53248
  v_mul_f32 v103, s27, v103
  v_exp_f32 v102, v102
  v_mfma_f32_16x16x32_bf16 v[116:119], a[120:123], a[40:43], v[116:119]
  v_exp_f32 v103, v103
  v_mfma_f32_16x16x32_bf16 v[116:119], a[116:119], a[36:39], v[116:119]
  ds_read_b64_tr_b16 a[152:153], v26 offset:49152
  v_cvt_pk_bf16_f32 v83, v102, v103
  v_mfma_f32_16x16x32_bf16 v[116:119], a[112:115], a[32:35], v[116:119]
  s_waitcnt lgkmcnt(11)
  v_mul_f32 v112, s27, v112
  v_mul_f32 v113, s27, v113
  v_mfma_f32_16x16x32_bf16 v[128:131], a[128:131], v[80:83], v[128:131]
  v_exp_f32 v112, v112
  v_mfma_f32_16x16x32_bf16 v[160:163], a[128:131], v[84:87], v[160:163]
  s_waitcnt lgkmcnt(9)
  ds_read_b64_tr_b16 a[154:155], v26 offset:53248
  v_mul_f32 v114, s27, v114
  v_mfma_f32_16x16x32_bf16 v[132:135], a[132:135], v[80:83], v[132:135]
  buffer_store_dwordx4 a[208:211], v40, s[16:19], s78 offen offset:0 nt
  ds_read_b64_tr_b16 a[156:157], v27 offset:49152
  v_exp_f32 v113, v113
  v_mfma_f32_16x16x32_bf16 v[164:167], a[132:135], v[84:87], v[164:167]
  s_waitcnt lgkmcnt(9)
  ds_read_b128 a[96:99], v16 offset:57344
  v_cvt_pk_bf16_f32 v88, v112, v113
  v_mfma_f32_16x16x32_bf16 v[136:139], a[136:139], v[80:83], v[136:139]
  v_exp_f32 v114, v114
  v_mfma_f32_16x16x32_bf16 v[168:171], a[136:139], v[84:87], v[168:171]
  ds_read_b64_tr_b16 a[158:159], v27 offset:53248
  v_mul_f32 v115, s27, v115
  v_mfma_f32_16x16x32_bf16 a[224:227], a[240:243], v[80:83], a[224:227]
  s_waitcnt lgkmcnt(9)
  v_exp_f32 v115, v115
  v_mfma_f32_16x16x32_bf16 v[140:143], a[140:143], v[80:83], v[140:143]
  v_mul_f32 v120, s27, v120
  v_cvt_pk_bf16_f32 v89, v114, v115
  v_mfma_f32_16x16x32_bf16 v[172:175], a[140:143], v[84:87], v[172:175]
  s_waitcnt lgkmcnt(7)
  ds_read_b128 a[100:103], v17 offset:57344
  v_mul_f32 v121, s27, v121
  v_mfma_f32_16x16x32_bf16 v[144:147], a[144:147], v[80:83], v[144:147]
  v_exp_f32 v120, v120
  v_mfma_f32_16x16x32_bf16 v[176:179], a[144:147], v[84:87], v[176:179]
  s_waitcnt lgkmcnt(6)
  buffer_store_dwordx4 a[212:215], v40, s[16:19], s78 offen offset:1024 nt
  ds_read_b128 a[104:107], v18 offset:57344
  v_exp_f32 v121, v121
  v_mfma_f32_16x16x32_bf16 v[148:151], a[148:151], v[80:83], v[148:151]
  v_mul_f32 v122, s27, v122
  v_cvt_pk_bf16_f32 v92, v120, v121
  v_mfma_f32_16x16x32_bf16 v[180:183], a[148:151], v[84:87], v[180:183]
  v_exp_f32 v122, v122
  v_mfma_f32_16x16x32_bf16 a[228:231], a[240:243], v[84:87], a[228:231]
  s_waitcnt lgkmcnt(5)
  ds_read_b128 a[108:111], v19 offset:57344
  v_mul_f32 v123, s27, v123
  v_mfma_f32_16x16x32_bf16 v[152:155], a[152:155], v[80:83], v[152:155]
  v_exp_f32 v123, v123
  v_mfma_f32_16x16x32_bf16 v[184:187], a[152:155], v[84:87], v[184:187]
  s_waitcnt lgkmcnt(3)
  ds_read_b128 a[112:115], v16 offset:61440
  v_mul_f32 v124, s27, v124
  v_cvt_pk_bf16_f32 v93, v122, v123
  v_mfma_f32_16x16x32_bf16 v[156:159], a[156:159], v[80:83], v[156:159]
  v_exp_f32 v124, v124
  v_mul_f32 v125, s27, v125
  v_mfma_f32_16x16x32_bf16 v[188:191], a[156:159], v[84:87], v[188:191]
  ds_read_b128 a[116:119], v17 offset:61440
  v_exp_f32 v125, v125
  v_mfma_f32_16x16x32_bf16 v[96:99], a[96:99], a[0:3], 0
  s_waitcnt lgkmcnt(4)
  v_mul_f32 v126, s27, v126
  v_cvt_pk_bf16_f32 v94, v124, v125
  v_mfma_f32_16x16x32_bf16 v[96:99], a[100:103], a[4:7], v[96:99]
  s_waitcnt lgkmcnt(3)
  ds_read_b128 a[120:123], v18 offset:61440
  v_mul_f32 v127, s27, v127
  v_mfma_f32_16x16x32_bf16 v[96:99], a[104:107], a[8:11], v[96:99]
  s_waitcnt lgkmcnt(3)
  v_exp_f32 v126, v126
  v_mfma_f32_16x16x32_bf16 v[96:99], a[108:111], a[12:15], v[96:99]
  v_exp_f32 v127, v127
  v_mfma_f32_16x16x32_bf16 v[104:107], a[108:111], a[28:31], 0
  ds_read_b128 a[124:127], v19 offset:61440
  v_mul_f32 v116, s27, v116
  v_mfma_f32_16x16x32_bf16 v[104:107], a[104:107], a[24:27], v[104:107]
  v_cvt_pk_bf16_f32 v95, v126, v127
  v_mul_f32 v117, s27, v117
  v_mfma_f32_16x16x32_bf16 v[104:107], a[100:103], a[20:23], v[104:107]
  s_add_u32 m0, s29, 0
  v_exp_f32 v116, v116
  v_mfma_f32_16x16x32_bf16 v[104:107], a[96:99], a[16:19], v[104:107]
  s_waitcnt lgkmcnt(3)
  v_exp_f32 v117, v117
  v_mfma_f32_16x16x32_bf16 v[108:111], a[112:115], a[16:19], 0
  s_waitcnt lgkmcnt(2)
  v_mul_f32 v118, s27, v118
  v_cvt_pk_bf16_f32 v90, v116, v117
  v_mfma_f32_16x16x32_bf16 v[108:111], a[116:119], a[20:23], v[108:111]
  s_waitcnt lgkmcnt(1)
  buffer_load_dwordx4 v28, s[8:11], s21 offen offset:0 nt lds
  v_mfma_f32_16x16x32_bf16 v[108:111], a[120:123], a[24:27], v[108:111]
  s_waitcnt lgkmcnt(0)
  v_exp_f32 v118, v118
  v_mfma_f32_16x16x32_bf16 v[108:111], a[124:127], a[28:31], v[108:111]
  v_mul_f32 v119, s27, v119
  v_mul_f32 v96, s27, v96
  v_mfma_f32_16x16x32_bf16 v[100:103], a[124:127], a[12:15], 0
  v_exp_f32 v119, v119
  v_mfma_f32_16x16x32_bf16 v[100:103], a[120:123], a[8:11], v[100:103]
  v_cvt_pk_bf16_f32 v91, v118, v119
  v_mul_f32 v97, s27, v97
  v_mfma_f32_16x16x32_bf16 v[100:103], a[116:119], a[4:7], v[100:103]
  v_exp_f32 v96, v96
  v_mfma_f32_16x16x32_bf16 v[100:103], a[112:115], a[0:3], v[100:103]
  s_waitcnt vmcnt(19)
  v_exp_f32 v97, v97
  v_mfma_f32_16x16x32_bf16 v[192:195], a[128:131], v[88:91], v[192:195]
  ds_read_b128 a[0:3], v30 offset:0
  v_mul_f32 v98, s27, v98
  v_mfma_f32_16x16x32_bf16 v[224:227], a[128:131], v[92:95], v[224:227]
  buffer_load_dwordx4 v29, s[8:11], s21 offen offset:1024 nt lds
  v_mfma_f32_16x16x32_bf16 v[196:199], a[132:135], v[88:91], v[196:199]
  s_add_u32 s29, s29, 8192
  ds_read_b64_tr_b16 a[128:129], v20 offset:57344
  v_cvt_pk_bf16_f32 v80, v96, v97
  v_mfma_f32_16x16x32_bf16 v[228:231], a[132:135], v[92:95], v[228:231]
  s_and_b32 s29, s29, 0xffff
  v_exp_f32 v98, v98
  v_mfma_f32_16x16x32_bf16 v[200:203], a[136:139], v[88:91], v[200:203]
  s_add_u32 s55, s55, 2048
  ds_read_b64_tr_b16 a[130:131], v20 offset:61440
  v_mul_f32 v99, s27, v99
  v_mfma_f32_16x16x32_bf16 v[232:235], a[136:139], v[92:95], v[232:235]
  s_and_b32 s55, s55, 32767
  v_exp_f32 v99, v99
  v_mfma_f32_16x16x32_bf16 a[232:235], a[240:243], v[88:91], a[232:235]
  s_add_u32 s21, s80, s55
  v_mul_f32 v104, s27, v104
  v_cvt_pk_bf16_f32 v81, v98, v99
  v_mfma_f32_16x16x32_bf16 v[204:207], a[140:143], v[88:91], v[204:207]
  ds_read_b128 a[4:7], v31 offset:0
  ds_read_b64_tr_b16 a[132:133], v21 offset:57344
  v_mfma_f32_16x16x32_bf16 v[236:239], a[140:143], v[92:95], v[236:239]
  s_add_u32 m0, s49, 65536
  v_exp_f32 v104, v104
  v_mfma_f32_16x16x32_bf16 v[208:211], a[144:147], v[88:91], v[208:211]
  buffer_load_dwordx4 v28, s[12:15], s22 offen offset:0 nt lds
  v_mfma_f32_16x16x32_bf16 v[240:243], a[144:147], v[92:95], v[240:243]
  ds_read_b64_tr_b16 a[134:135], v21 offset:61440
  v_mul_f32 v105, s27, v105
  v_mfma_f32_16x16x32_bf16 v[212:215], a[148:151], v[88:91], v[212:215]
  v_exp_f32 v105, v105
  v_mfma_f32_16x16x32_bf16 v[244:247], a[148:151], v[92:95], v[244:247]
  v_mul_f32 v106, s27, v106
  v_cvt_pk_bf16_f32 v84, v104, v105
  v_mfma_f32_16x16x32_bf16 a[236:239], a[240:243], v[92:95], a[236:239]
  ds_read_b128 a[8:11], v32 offset:0
  v_exp_f32 v106, v106
  v_mfma_f32_16x16x32_bf16 v[216:219], a[152:155], v[88:91], v[216:219]
  ds_read_b64_tr_b16 a[136:137], v22 offset:57344
  v_mul_f32 v107, s27, v107
  v_mul_f32 v100, s27, v100
  v_mfma_f32_16x16x32_bf16 v[248:251], a[152:155], v[92:95], v[248:251]
  v_exp_f32 v107, v107
  v_mul_f32 v101, s27, v101
  v_mfma_f32_16x16x32_bf16 v[220:223], a[156:159], v[88:91], v[220:223]
  ds_read_b64_tr_b16 a[138:139], v22 offset:61440
  v_mul_f32 v108, s27, v108
  v_cvt_pk_bf16_f32 v85, v106, v107
  v_mfma_f32_16x16x32_bf16 v[252:255], a[156:159], v[92:95], v[252:255]
  buffer_load_dwordx4 v29, s[12:15], s22 offen offset:1024 nt lds
  v_mfma_f32_16x16x32_bf16 v[112:115], a[96:99], a[32:35], 0
  s_add_u32 s49, s49, 8192
  v_exp_f32 v108, v108
  v_mul_f32 v109, s27, v109
  v_mfma_f32_16x16x32_bf16 v[112:115], a[100:103], a[36:39], v[112:115]
  s_and_b32 s49, s49, 0xffff
  ds_read_b128 a[12:15], v33 offset:0
  ds_read_b64_tr_b16 a[140:141], v23 offset:57344
  v_mul_f32 v102, s27, v102
  v_mfma_f32_16x16x32_bf16 v[112:115], a[104:107], a[40:43], v[112:115]
  s_add_u32 s56, s56, 2048
  v_exp_f32 v109, v109
  v_mul_f32 v110, s27, v110
  v_mfma_f32_16x16x32_bf16 v[112:115], a[108:111], a[44:47], v[112:115]
  s_and_b32 s56, s56, 32767
  ds_read_b64_tr_b16 a[142:143], v23 offset:61440
  v_cvt_pk_bf16_f32 v86, v108, v109
  v_mul_f32 v103, s27, v103
  v_mfma_f32_16x16x32_bf16 v[120:123], a[108:111], a[60:63], 0
  s_add_u32 s22, s81, s56
  v_exp_f32 v110, v110
  v_mul_f32 v111, s27, v111
  v_mfma_f32_16x16x32_bf16 v[120:123], a[104:107], a[56:59], v[120:123]
  ds_read_b128 a[16:19], v30 offset:4096
  v_exp_f32 v111, v111
  v_mfma_f32_16x16x32_bf16 v[120:123], a[100:103], a[52:55], v[120:123]
  ds_read_b64_tr_b16 a[144:145], v24 offset:57344
  v_cvt_pk_bf16_f32 v87, v110, v111
  v_exp_f32 v100, v100
  v_mfma_f32_16x16x32_bf16 v[120:123], a[96:99], a[48:51], v[120:123]
  ds_read_b64_tr_b16 a[146:147], v24 offset:61440
  ds_read_b128 a[20:23], v31 offset:4096
  v_mfma_f32_16x16x32_bf16 v[124:127], a[112:115], a[48:51], 0
  v_exp_f32 v101, v101
  v_exp_f32 v102, v102
  v_mfma_f32_16x16x32_bf16 v[124:127], a[116:119], a[52:55], v[124:127]
  ds_read_b64_tr_b16 a[148:149], v25 offset:57344
  v_cvt_pk_bf16_f32 v82, v100, v101
  v_mfma_f32_16x16x32_bf16 v[124:127], a[120:123], a[56:59], v[124:127]
  ds_read_b64_tr_b16 a[150:151], v25 offset:61440
  v_exp_f32 v103, v103
  v_mfma_f32_16x16x32_bf16 v[124:127], a[124:127], a[60:63], v[124:127]
  ds_read_b128 a[24:27], v32 offset:4096
  ds_read_b64_tr_b16 a[152:153], v26 offset:57344
  v_cvt_pk_bf16_f32 v83, v102, v103
  v_mfma_f32_16x16x32_bf16 v[116:119], a[124:127], a[44:47], 0
  ds_read_b64_tr_b16 a[154:155], v26 offset:61440
  v_mul_f32 v112, s27, v112
  v_mul_f32 v113, s27, v113
  v_mfma_f32_16x16x32_bf16 v[116:119], a[120:123], a[40:43], v[116:119]
  ds_read_b64_tr_b16 a[156:157], v27 offset:57344
  v_exp_f32 v112, v112
  v_mfma_f32_16x16x32_bf16 v[116:119], a[116:119], a[36:39], v[116:119]
  ds_read_b64_tr_b16 a[158:159], v27 offset:61440
  v_exp_f32 v113, v113
  v_mfma_f32_16x16x32_bf16 v[116:119], a[112:115], a[32:35], v[116:119]
  s_waitcnt lgkmcnt(15)
  ds_read_b128 a[28:31], v33 offset:4096
  ds_read_b128 a[96:99], v16 offset:0
  v_mul_f32 v114, s27, v114
  v_mfma_f32_16x16x32_bf16 v[128:131], a[128:131], v[80:83], v[128:131]
  ds_read_b128 a[100:103], v17 offset:0
  v_accvgpr_mov_b32 a32, a64
  v_accvgpr_mov_b32 a33, a65
  v_mfma_f32_16x16x32_bf16 v[160:163], a[128:131], v[84:87], v[160:163]
  ds_read_b128 a[104:107], v18 offset:0
  v_cvt_pk_bf16_f32 v88, v112, v113
  v_accvgpr_mov_b32 a34, a66
  v_mfma_f32_16x16x32_bf16 v[132:135], a[132:135], v[80:83], v[132:135]
  buffer_store_dwordx4 a[216:219], v40, s[16:19], s79 offen offset:0 nt
  v_exp_f32 v114, v114
  v_accvgpr_mov_b32 a35, a67
  v_mfma_f32_16x16x32_bf16 v[164:167], a[132:135], v[84:87], v[164:167]
  s_waitcnt lgkmcnt(15)
  v_mul_f32 v115, s27, v115
  v_accvgpr_mov_b32 a36, a68
  v_mfma_f32_16x16x32_bf16 v[136:139], a[136:139], v[80:83], v[136:139]
  v_exp_f32 v115, v115
  v_mfma_f32_16x16x32_bf16 v[168:171], a[136:139], v[84:87], v[168:171]
  v_accvgpr_mov_b32 a37, a69
  v_mul_f32 v120, s27, v120
  v_mfma_f32_16x16x32_bf16 a[224:227], a[240:243], v[80:83], a[224:227]
  ds_read_b128 a[108:111], v19 offset:0
  v_cvt_pk_bf16_f32 v89, v114, v115
  v_accvgpr_mov_b32 a38, a70
  v_mfma_f32_16x16x32_bf16 v[140:143], a[140:143], v[80:83], v[140:143]
  v_exp_f32 v120, v120
  v_accvgpr_mov_b32 a39, a71
  v_mfma_f32_16x16x32_bf16 v[172:175], a[140:143], v[84:87], v[172:175]
  s_waitcnt lgkmcnt(13)
  v_mul_f32 v121, s27, v121
  v_accvgpr_mov_b32 a40, a72
  v_exp_f32 v121, v121
  v_mfma_f32_16x16x32_bf16 v[144:147], a[144:147], v[80:83], v[144:147]
  v_accvgpr_mov_b32 a41, a73
  v_mul_f32 v122, s27, v122
  v_mfma_f32_16x16x32_bf16 v[176:179], a[144:147], v[84:87], v[176:179]
  s_waitcnt lgkmcnt(10)
  buffer_store_dwordx4 a[220:223], v40, s[16:19], s79 offen offset:1024 nt
  v_cvt_pk_bf16_f32 v92, v120, v121
  v_accvgpr_mov_b32 a42, a74
  v_accvgpr_mov_b32 a43, a75
  v_mfma_f32_16x16x32_bf16 v[148:151], a[148:151], v[80:83], v[148:151]
  s_add_u32 s72, s72, 16777216
  v_exp_f32 v122, v122
  v_mfma_f32_16x16x32_bf16 v[180:183], a[148:151], v[84:87], v[180:183]
  s_add_u32 s73, s73, 16777216
  v_mul_f32 v123, s27, v123
  v_accvgpr_mov_b32 a44, a76
  v_mfma_f32_16x16x32_bf16 a[228:231], a[240:243], v[84:87], a[228:231]
  s_waitcnt lgkmcnt(7)
  v_exp_f32 v123, v123
  v_mfma_f32_16x16x32_bf16 v[152:155], a[152:155], v[80:83], v[152:155]
  s_add_u32 s74, s74, 16777216
  ds_read_b128 a[112:115], v16 offset:4096
  v_accvgpr_mov_b32 a45, a77
  v_mul_f32 v124, s27, v124
  v_mfma_f32_16x16x32_bf16 v[184:187], a[152:155], v[84:87], v[184:187]
  s_waitcnt lgkmcnt(6)
  v_cvt_pk_bf16_f32 v93, v122, v123
  v_accvgpr_mov_b32 a46, a78
  v_exp_f32 v124, v124
  v_mfma_f32_16x16x32_bf16 v[156:159], a[156:159], v[80:83], v[156:159]
  s_add_u32 s75, s75, 16777216
  v_accvgpr_mov_b32 a47, a79
  v_mul_f32 v125, s27, v125
  v_mfma_f32_16x16x32_bf16 v[188:191], a[156:159], v[84:87], v[188:191]
  s_waitcnt lgkmcnt(4)
  ds_read_b128 a[116:119], v17 offset:4096
  v_exp_f32 v125, v125
  s_add_u32 s76, s76, 16777216
  s_add_u32 s77, s77, 16777216
  s_add_u32 s78, s78, 16777216
  s_add_u32 s79, s79, 16777216
  s_mov_b32 s18, s48
  s_sub_u32 s47, s47, 1
  s_cbranch_scc0 L_it0
  v_mul_f32 v126, s27, v126
  v_mul_f32 v127, s27, v127
  v_mul_f32 v116, s27, v116
  v_mul_f32 v117, s27, v117
  v_mul_f32 v118, s27, v118
  v_mul_f32 v119, s27, v119
  v_exp_f32 v126, v126
  v_exp_f32 v127, v127
  v_exp_f32 v116, v116
  v_exp_f32 v117, v117
  v_exp_f32 v118, v118
  v_exp_f32 v119, v119
  s_nop 0
  v_cvt_pk_bf16_f32 v94, v124, v125
  v_cvt_pk_bf16_f32 v95, v126, v127
  v_cvt_pk_bf16_f32 v90, v116, v117
  v_cvt_pk_bf16_f32 v91, v118, v119
  v_accvgpr_read_b32 v42, a224
  v_accvgpr_read_b32 v43, a228
  v_rcp_f32 v44, v42
  v_rcp_f32 v46, v43
  v_subrev_u32 v36, s34, v42
  v_subrev_u32 v37, s34, v43
  v_cmp_le_u32 vcc, s35, v36
  v_cmp_le_u32 s[32:33], s35, v37
  v_pk_mul_f32 v[128:129], v[128:129], v[44:45] op_sel_hi:[1,0]
  v_pk_mul_f32 v[130:131], v[130:131], v[44:45] op_sel_hi:[1,0]
  v_pk_mul_f32 v[132:133], v[132:133], v[44:45] op_sel_hi:[1,0]
  v_pk_mul_f32 v[134:135], v[134:135], v[44:45] op_sel_hi:[1,0]
  v_pk_mul_f32 v[136:137], v[136:137], v[44:45] op_sel_hi:[1,0]
  v_pk_mul_f32 v[138:139], v[138:139], v[44:45] op_sel_hi:[1,0]
  v_pk_mul_f32 v[140:141], v[140:141], v[44:45] op_sel_hi:[1,0]
  v_pk_mul_f32 v[142:143], v[142:143], v[44:45] op_sel_hi:[1,0]
  v_pk_mul_f32 v[144:145], v[144:145], v[44:45] op_sel_hi:[1,0]
  v_pk_mul_f32 v[146:147], v[146:147], v[44:45] op_sel_hi:[1,0]
  v_pk_mul_f32 v[148:149], v[148:149], v[44:45] op_sel_hi:[1,0]
  v_pk_mul_f32 v[150:151], v[150:151], v[44:45] op_sel_hi:[1,0]
  v_pk_mul_f32 v[152:153], v[152:153], v[44:45] op_sel_hi:[1,0]
  v_pk_mul_f32 v[154:155], v[154:155], v[44:45] op_sel_hi:[1,0]
  v_pk_mul_f32 v[156:157], v[156:157], v[44:45] op_sel_hi:[1,0]
  v_pk_mul_f32 v[158:159], v[158:159], v[44:45] op_sel_hi:[1,0]
  v_pk_mul_f32 v[160:161], v[160:161], v[46:47] op_sel_hi:[1,0]
  v_pk_mul_f32 v[162:163], v[162:163], v[46:47] op_sel_hi:[1,0]
  v_pk_mul_f32 v[164:165], v[164:165], v[46:47] op_sel_hi:[1,0]
  v_pk_mul_f32 v[166:167], v[166:167], v[46:47] op_sel_hi:[1,0]
  v_pk_mul_f32 v[168:169], v[168:169], v[46:47] op_sel_hi:[1,0]
  v_pk_mul_f32 v[170:171], v[170:171], v[46:47] op_sel_hi:[1,0]
  v_pk_mul_f32 v[172:173], v[172:173], v[46:47] op_sel_hi:[1,0]
  v_pk_mul_f32 v[174:175], v[174:175], v[46:47] op_sel_hi:[1,0]
  v_pk_mul_f32 v[176:177], v[176:177], v[46:47] op_sel_hi:[1,0]
  v_pk_mul_f32 v[178:179], v[178:179], v[46:47] op_sel_hi:[1,0]
  v_pk_mul_f32 v[180:181], v[180:181], v[46:47] op_sel_hi:[1,0]
  v_pk_mul_f32 v[182:183], v[182:183], v[46:47] op_sel_hi:[1,0]
  v_pk_mul_f32 v[184:185], v[184:185], v[46:47] op_sel_hi:[1,0]
  v_pk_mul_f32 v[186:187], v[186:187], v[46:47] op_sel_hi:[1,0]
  v_pk_mul_f32 v[188:189], v[188:189], v[46:47] op_sel_hi:[1,0]
  v_pk_mul_f32 v[190:191], v[190:191], v[46:47] op_sel_hi:[1,0]
  v_cvt_pk_bf16_f32 v128, v128, v129
  v_cvt_pk_bf16_f32 v129, v130, v131
  v_cvt_pk_bf16_f32 v130, v132, v133
  v_cvt_pk_bf16_f32 v131, v134, v135
  v_cvt_pk_bf16_f32 v136, v136, v137
  v_cvt_pk_bf16_f32 v137, v138, v139
  v_cvt_pk_bf16_f32 v138, v140, v141
  v_cvt_pk_bf16_f32 v139, v142, v143
  v_mfma_f32_16x16x32_bf16 a[248:251], a[244:247], v[128:131], 0
  s_or_b64 s[30:31], s[30:31], vcc
  v_cvt_pk_bf16_f32 v144, v144, v145
  v_cvt_pk_bf16_f32 v145, v146, v147
  v_cvt_pk_bf16_f32 v146, v148, v149
  v_cvt_pk_bf16_f32 v147, v150, v151
  v_mfma_f32_16x16x32_bf16 a[248:251], a[244:247], v[136:139], a[248:251]
  s_or_b64 s[30:31], s[30:31], s[32:33]
  v_cvt_pk_bf16_f32 v152, v152, v153
  v_cvt_pk_bf16_f32 v153, v154, v155
  v_cvt_pk_bf16_f32 v154, v156, v157
  v_cvt_pk_bf16_f32 v155, v158, v159
  v_mfma_f32_16x16x32_bf16 a[248:251], a[244:247], v[144:147], a[248:251]
  v_cvt_pk_bf16_f32 v160, v160, v161
  v_cvt_pk_bf16_f32 v161, v162, v163
  v_cvt_pk_bf16_f32 v162, v164, v165
  v_cvt_pk_bf16_f32 v163, v166, v167
  v_mfma_f32_16x16x32_bf16 a[248:251], a[244:247], v[152:155], a[248:251]
  v_cvt_pk_bf16_f32 v168, v168, v169
  v_cvt_pk_bf16_f32 v169, v170, v171
  v_cvt_pk_bf16_f32 v170, v172, v173
  v_cvt_pk_bf16_f32 v171, v174, v175
  v_mfma_f32_16x16x32_bf16 a[248:251], a[244:247], v[160:163], a[248:251]
  v_cvt_pk_bf16_f32 v176, v176, v177
  v_cvt_pk_bf16_f32 v177, v178, v179
  v_cvt_pk_bf16_f32 v178, v180, v181
  v_cvt_pk_bf16_f32 v179, v182, v183
  v_mfma_f32_16x16x32_bf16 a[248:251], a[244:247], v[168:171], a[248:251]
  v_cvt_pk_bf16_f32 v184, v184, v185
  v_cvt_pk_bf16_f32 v185, v186, v187
  v_cvt_pk_bf16_f32 v186, v188, v189
  v_cvt_pk_bf16_f32 v187, v190, v191
  v_mfma_f32_16x16x32_bf16 a[248:251], a[244:247], v[176:179], a[248:251]
  s_nop 1
  v_mfma_f32_16x16x32_bf16 a[248:251], a[244:247], v[184:187], a[248:251]
  v_mfma_f32_16x16x32_bf16 v[192:195], a[128:131], v[88:91], v[192:195]
  ds_write_b128 v34, v[128:131] offset:0
  v_mfma_f32_16x16x32_bf16 v[224:227], a[128:131], v[92:95], v[224:227]
  ds_write_b128 v35, v[136:139] offset:0
  v_mfma_f32_16x16x32_bf16 v[196:199], a[132:135], v[88:91], v[196:199]
  ds_write_b128 v34, v[144:147] offset:128
  v_mfma_f32_16x16x32_bf16 v[228:231], a[132:135], v[92:95], v[228:231]
  ds_write_b128 v35, v[152:155] offset:128
  v_mfma_f32_16x16x32_bf16 v[200:203], a[136:139], v[88:91], v[200:203]
  ds_write_b128 v34, v[160:163] offset:4096
  v_mfma_f32_16x16x32_bf16 v[232:235], a[136:139], v[92:95], v[232:235]
  ds_write_b128 v35, v[168:171] offset:4096
  v_mfma_f32_16x16x32_bf16 a[232:235], a[240:243], v[88:91], a[232:235]
  ds_write_b128 v34, v[176:179] offset:4224
  v_mfma_f32_16x16x32_bf16 v[204:207], a[140:143], v[88:91], v[204:207]
  ds_write_b128 v35, v[184:187] offset:4224
  v_mfma_f32_16x16x32_bf16 v[236:239], a[140:143], v[92:95], v[236:239]
  ds_read_b64 a[160:161], v8 offset:0
  ds_read_b64 a[162:163], v9 offset:0
  v_mfma_f32_16x16x32_bf16 v[208:211], a[144:147], v[88:91], v[208:211]
  ds_read_b64 a[164:165], v10 offset:1024
  ds_read_b64 a[166:167], v11 offset:1024
  v_mfma_f32_16x16x32_bf16 v[240:243], a[144:147], v[92:95], v[240:243]
  ds_read_b64 a[168:169], v8 offset:2048
  ds_read_b64 a[170:171], v9 offset:2048
  v_mfma_f32_16x16x32_bf16 v[212:215], a[148:151], v[88:91], v[212:215]
  ds_read_b64 a[172:173], v10 offset:3072
  ds_read_b64 a[174:175], v11 offset:3072
  v_mfma_f32_16x16x32_bf16 v[244:247], a[148:151], v[92:95], v[244:247]
  ds_read_b64 a[176:177], v8 offset:4096
  ds_read_b64 a[178:179], v9 offset:4096
  v_mfma_f32_16x16x32_bf16 a[236:239], a[240:243], v[92:95], a[236:239]
  ds_read_b64 a[180:181], v10 offset:5120
  ds_read_b64 a[182:183], v11 offset:5120
  v_mfma_f32_16x16x32_bf16 v[216:219], a[152:155], v[88:91], v[216:219]
  ds_read_b64 a[184:185], v8 offset:6144
  ds_read_b64 a[186:187], v9 offset:6144
  v_mfma_f32_16x16x32_bf16 v[248:251], a[152:155], v[92:95], v[248:251]
  ds_read_b64 a[188:189], v10 offset:7168
  ds_read_b64 a[190:191], v11 offset:7168
  v_mfma_f32_16x16x32_bf16 v[220:223], a[156:159], v[88:91], v[220:223]
  v_mfma_f32_16x16x32_bf16 v[252:255], a[156:159], v[92:95], v[252:255]
  s_waitcnt lgkmcnt(8)
  buffer_store_dwordx4 a[160:163], v40, s[16:19], s72 offen offset:0 nt
  buffer_store_dwordx4 a[164:167], v40, s[16:19], s72 offen offset:1024 nt
  buffer_store_dwordx4 a[168:171], v40, s[16:19], s73 offen offset:0 nt
  buffer_store_dwordx4 a[172:175], v40, s[16:19], s73 offen offset:1024 nt
  v_accvgpr_read_b32 v42, a232
  v_accvgpr_read_b32 v43, a236
  v_rcp_f32 v44, v42
  v_rcp_f32 v46, v43
  v_subrev_u32 v36, s34, v42
  v_subrev_u32 v37, s34, v43
  v_cmp_le_u32 vcc, s35, v36
  v_cmp_le_u32 s[32:33], s35, v37
  v_pk_mul_f32 v[192:193], v[192:193], v[44:45] op_sel_hi:[1,0]
  v_pk_mul_f32 v[194:195], v[194:195], v[44:45] op_sel_hi:[1,0]
  v_pk_mul_f32 v[196:197], v[196:197], v[44:45] op_sel_hi:[1,0]
  v_pk_mul_f32 v[198:199], v[198:199], v[44:45] op_sel_hi:[1,0]
  v_pk_mul_f32 v[200:201], v[200:201], v[44:45] op_sel_hi:[1,0]
  v_pk_mul_f32 v[202:203], v[202:203], v[44:45] op_sel_hi:[1,0]
  v_pk_mul_f32 v[204:205], v[204:205], v[44:45] op_sel_hi:[1,0]
  v_pk_mul_f32 v[206:207], v[206:207], v[44:45] op_sel_hi:[1,0]
  v_pk_mul_f32 v[208:209], v[208:209], v[44:45] op_sel_hi:[1,0]
  v_pk_mul_f32 v[210:211], v[210:211], v[44:45] op_sel_hi:[1,0]
  v_pk_mul_f32 v[212:213], v[212:213], v[44:45] op_sel_hi:[1,0]
  v_pk_mul_f32 v[214:215], v[214:215], v[44:45] op_sel_hi:[1,0]
  v_pk_mul_f32 v[216:217], v[216:217], v[44:45] op_sel_hi:[1,0]
  v_pk_mul_f32 v[218:219], v[218:219], v[44:45] op_sel_hi:[1,0]
  v_pk_mul_f32 v[220:221], v[220:221], v[44:45] op_sel_hi:[1,0]
  v_pk_mul_f32 v[222:223], v[222:223], v[44:45] op_sel_hi:[1,0]
  v_pk_mul_f32 v[224:225], v[224:225], v[46:47] op_sel_hi:[1,0]
  v_pk_mul_f32 v[226:227], v[226:227], v[46:47] op_sel_hi:[1,0]
  v_pk_mul_f32 v[228:229], v[228:229], v[46:47] op_sel_hi:[1,0]
  v_pk_mul_f32 v[230:231], v[230:231], v[46:47] op_sel_hi:[1,0]
  v_pk_mul_f32 v[232:233], v[232:233], v[46:47] op_sel_hi:[1,0]
  v_pk_mul_f32 v[234:235], v[234:235], v[46:47] op_sel_hi:[1,0]
  v_pk_mul_f32 v[236:237], v[236:237], v[46:47] op_sel_hi:[1,0]
  v_pk_mul_f32 v[238:239], v[238:239], v[46:47] op_sel_hi:[1,0]
  v_pk_mul_f32 v[240:241], v[240:241], v[46:47] op_sel_hi:[1,0]
  v_pk_mul_f32 v[242:243], v[242:243], v[46:47] op_sel_hi:[1,0]
  v_pk_mul_f32 v[244:245], v[244:245], v[46:47] op_sel_hi:[1,0]
  v_pk_mul_f32 v[246:247], v[246:247], v[46:47] op_sel_hi:[1,0]
  v_pk_mul_f32 v[248:249], v[248:249], v[46:47] op_sel_hi:[1,0]
  v_pk_mul_f32 v[250:251], v[250:251], v[46:47] op_sel_hi:[1,0]
  v_pk_mul_f32 v[252:253], v[252:253], v[46:47] op_sel_hi:[1,0]
  v_pk_mul_f32 v[254:255], v[254:255], v[46:47] op_sel_hi:[1,0]
  s_waitcnt lgkmcnt(0)
  buffer_store_dwordx4 a[176:179], v40, s[16:19], s74 offen offset:0 nt
  buffer_store_dwordx4 a[180:183], v40, s[16:19], s74 offen offset:1024 nt
  buffer_store_dwordx4 a[184:187], v40, s[16:19], s75 offen offset:0 nt
  buffer_store_dwordx4 a[188:191], v40, s[16:19], s75 offen offset:1024 nt
  v_cvt_pk_bf16_f32 v192, v192, v193
  v_cvt_pk_bf16_f32 v193, v194, v195
  v_cvt_pk_bf16_f32 v194, v196, v197
  v_cvt_pk_bf16_f32 v195, v198, v199
  v_cvt_pk_bf16_f32 v200, v200, v201
  v_cvt_pk_bf16_f32 v201, v202, v203
  v_cvt_pk_bf16_f32 v202, v204, v205
  v_cvt_pk_bf16_f32 v203, v206, v207
  v_mfma_f32_16x16x32_bf16 a[248:251], a[244:247], v[192:195], a[248:251]
  s_or_b64 s[30:31], s[30:31], vcc
  v_cvt_pk_bf16_f32 v208, v208, v209
  v_cvt_pk_bf16_f32 v209, v210, v211
  v_cvt_pk_bf16_f32 v210, v212, v213
  v_cvt_pk_bf16_f32 v211, v214, v215
  v_mfma_f32_16x16x32_bf16 a[248:251], a[244:247], v[200:203], a[248:251]
  s_or_b64 s[30:31], s[30:31], s[32:33]
  v_cvt_pk_bf16_f32 v216, v216, v217
  v_cvt_pk_bf16_f32 v217, v218, v219
  v_cvt_pk_bf16_f32 v218, v220, v221
  v_cvt_pk_bf16_f32 v219, v222, v223
  v_mfma_f32_16x16x32_bf16 a[248:251], a[244:247], v[208:211], a[248:251]
  v_cvt_pk_bf16_f32 v224, v224, v225
  v_cvt_pk_bf16_f32 v225, v226, v227
  v_cvt_pk_bf16_f32 v226, v228, v229
  v_cvt_pk_bf16_f32 v227, v230, v231
  v_mfma_f32_16x16x32_bf16 a[248:251], a[244:247], v[216:219], a[248:251]
  v_cvt_pk_bf16_f32 v232, v232, v233
  v_cvt_pk_bf16_f32 v233, v234, v235
  v_cvt_pk_bf16_f32 v234, v236, v237
  v_cvt_pk_bf16_f32 v235, v238, v239
  v_mfma_f32_16x16x32_bf16 a[248:251], a[244:247], v[224:227], a[248:251]
  v_cvt_pk_bf16_f32 v240, v240, v241
  v_cvt_pk_bf16_f32 v241, v242, v243
  v_cvt_pk_bf16_f32 v242, v244, v245
  v_cvt_pk_bf16_f32 v243, v246, v247
  v_mfma_f32_16x16x32_bf16 a[248:251], a[244:247], v[232:235], a[248:251]
  v_cvt_pk_bf16_f32 v248, v248, v249
  v_cvt_pk_bf16_f32 v249, v250, v251
  v_cvt_pk_bf16_f32 v250, v252, v253
  v_cvt_pk_bf16_f32 v251, v254, v255
  v_mfma_f32_16x16x32_bf16 a[248:251], a[244:247], v[240:243], a[248:251]
  s_nop 1
  v_mfma_f32_16x16x32_bf16 a[248:251], a[244:247], v[248:251], a[248:251]
  ds_write_b128 v34, v[192:195] offset:0
  ds_write_b128 v35, v[200:203] offset:0
  ds_write_b128 v34, v[208:211] offset:128
  ds_write_b128 v35, v[216:219] offset:128
  ds_read_b64 a[192:193], v8 offset:0
  ds_read_b64 a[194:195], v9 offset:0
  ds_read_b64 a[196:197], v10 offset:1024
  ds_read_b64 a[198:199], v11 offset:1024
  ds_read_b64 a[200:201], v8 offset:2048
  ds_read_b64 a[202:203], v9 offset:2048
  ds_read_b64 a[204:205], v10 offset:3072
  ds_read_b64 a[206:207], v11 offset:3072
  ds_write_b128 v34, v[224:227] offset:4096
  ds_write_b128 v35, v[232:235] offset:4096
  ds_write_b128 v34, v[240:243] offset:4224
  ds_write_b128 v35, v[248:251] offset:4224
  ds_read_b64 a[208:209], v8 offset:4096
  ds_read_b64 a[210:211], v9 offset:4096
  ds_read_b64 a[212:213], v10 offset:5120
  ds_read_b64 a[214:215], v11 offset:5120
  ds_read_b64 a[216:217], v8 offset:6144
  ds_read_b64 a[218:219], v9 offset:6144
  ds_read_b64 a[220:221], v10 offset:7168
  ds_read_b64 a[222:223], v11 offset:7168
  s_waitcnt lgkmcnt(15)
  buffer_store_dwordx4 a[192:195], v40, s[16:19], s76 offen offset:0 nt
  buffer_store_dwordx4 a[196:199], v40, s[16:19], s76 offen offset:1024 nt
  s_waitcnt lgkmcnt(12)
  buffer_store_dwordx4 a[200:203], v40, s[16:19], s77 offen offset:0 nt
  buffer_store_dwordx4 a[204:207], v40, s[16:19], s77 offen offset:1024 nt
  s_waitcnt lgkmcnt(4)
  buffer_store_dwordx4 a[208:211], v40, s[16:19], s78 offen offset:0 nt
  buffer_store_dwordx4 a[212:215], v40, s[16:19], s78 offen offset:1024 nt
  s_waitcnt lgkmcnt(0)
  buffer_store_dwordx4 a[216:219], v40, s[16:19], s79 offen offset:0 nt
  buffer_store_dwordx4 a[220:223], v40, s[16:19], s79 offen offset:1024 nt
  v_accvgpr_read_b32 v42, a248
  v_cmp_u_f32 vcc, v42, v42
  s_nop 1
  s_or_b64 s[30:31], s[30:31], vcc
  s_cmp_lg_u64 s[30:31], 0
  s_addc_u32 s28, s28, s28
  s_mov_b64 s[30:31], 0
  s_mov_b64 vcc, 0
  s_barrier
  s_cmp_eq_u32 s28, 0
  s_cbranch_scc1 L_end
  s_lshl_b32 s45, s20, 13
  v_add_u32 v16, s45, v16
  v_add_u32 v17, s45, v17
  v_add_u32 v18, s45, v18
  v_add_u32 v19, s45, v19
  v_add_u32 v20, s45, v20
  v_add_u32 v21, s45, v21
  v_add_u32 v22, s45, v22
  v_add_u32 v23, s45, v23
  v_add_u32 v24, s45, v24
  v_add_u32 v25, s45, v25
  v_add_u32 v26, s45, v26
  v_add_u32 v27, s45, v27
  s_add_u32 s46, s45, 65536
  s_lshl_b32 s25, s20, 14
  v_mov_b32 v62, v28
  v_mov_b32 v63, v29
  s_mov_b32 s47, 0
L_slow_unit:
  s_bitcmp1_b32 s28, 3
  s_cbranch_scc0 L_slow_next
  s_add_u32 s64, s25, 0
  s_mov_b32 s72, s64
  s_add_u32 s65, s25, 2048
  s_mov_b32 s73, s65
  s_add_u32 s66, s25, 4096
  s_mov_b32 s74, s66
  s_add_u32 s67, s25, 6144
  s_mov_b32 s75, s67
  s_add_u32 s68, s25, 8192
  s_mov_b32 s76, s68
  s_add_u32 s69, s25, 10240
  s_mov_b32 s77, s69
  s_add_u32 s70, s25, 12288
  s_mov_b32 s78, s70
  s_add_u32 s71, s25, 14336
  s_mov_b32 s79, s71
  s_waitcnt vmcnt(0) lgkmcnt(0)
  s_add_u32 m0, s44, 0
  s_nop 0
  buffer_load_dwordx4 v28, s[4:7], s64 offen offset:0 nt lds
  buffer_load_dwordx4 v29, s[4:7], s64 offen offset:1024 nt lds
  s_add_u32 m0, s44, 2048
  s_nop 0
  buffer_load_dwordx4 v28, s[4:7], s65 offen offset:0 nt lds
  buffer_load_dwordx4 v29, s[4:7], s65 offen offset:1024 nt lds
  s_add_u32 m0, s44, 4096
  s_nop 0
  buffer_load_dwordx4 v28, s[4:7], s66 offen offset:0 nt lds
  buffer_load_dwordx4 v29, s[4:7], s66 offen offset:1024 nt lds
  s_add_u32 m0, s44, 6144
  s_nop 0
  buffer_load_dwordx4 v28, s[4:7], s67 offen offset:0 nt lds
  buffer_load_dwordx4 v29, s[4:7], s67 offen offset:1024 nt lds
  s_waitcnt vmcnt(0) lgkmcnt(0)
  ds_read_b128 a[0:3], v30 offset:0
  ds_read_b128 a[4:7], v31 offset:0
  ds_read_b128 a[8:11], v32 offset:0
  ds_read_b128 a[12:15], v33 offset:0
  ds_read_b128 a[16:19], v30 offset:4096
  ds_read_b128 a[20:23], v31 offset:4096
  ds_read_b128 a[24:27], v32 offset:4096
  ds_read_b128 a[28:31], v33 offset:4096
  s_waitcnt vmcnt(0) lgkmcnt(0)
  s_add_u32 m0, s44, 0
  s_nop 0
  buffer_load_dwordx4 v28, s[4:7], s68 offen offset:0 nt lds
  buffer_load_dwordx4 v29, s[4:7], s68 offen offset:1024 nt lds
  s_add_u32 m0, s44, 2048
  s_nop 0
  buffer_load_dwordx4 v28, s[4:7], s69 offen offset:0 nt lds
  buffer_load_dwordx4 v29, s[4:7], s69 offen offset:1024 nt lds
  s_add_u32 m0, s44, 4096
  s_nop 0
  buffer_load_dwordx4 v28, s[4:7], s70 offen offset:0 nt lds
  buffer_load_dwordx4 v29, s[4:7], s70 offen offset:1024 nt lds
  s_add_u32 m0, s44, 6144
  s_nop 0
  buffer_load_dwordx4 v28, s[4:7], s71 offen offset:0 nt lds
  buffer_load_dwordx4 v29, s[4:7], s71 offen offset:1024 nt lds
  s_waitcnt vmcnt(0) lgkmcnt(0)
  ds_read_b128 a[32:35], v30 offset:0
  ds_read_b128 a[36:39], v31 offset:0
  ds_read_b128 a[40:43], v32 offset:0
  ds_read_b128 a[44:47], v33 offset:0
  ds_read_b128 a[48:51], v30 offset:4096
  ds_read_b128 a[52:55], v31 offset:4096
  ds_read_b128 a[56:59], v32 offset:4096
  ds_read_b128 a[60:63], v33 offset:4096
  s_waitcnt vmcnt(0) lgkmcnt(0)
  v_mov_b32 v50, 0xff800000
  v_mov_b32 v51, 0xff800000
  v_mov_b32 v52, 0xff800000
  v_mov_b32 v53, 0xff800000
  s_mov_b32 s21, s47
  s_add_u32 s22, s47, 131072
L_slow_p1:
  s_add_u32 m0, s45, 0
  s_add_u32 s54, s21, 0
  buffer_load_dwordx4 v62, s[8:11], s54 offen offset:0 lds
  buffer_load_dwordx4 v63, s[8:11], s54 offen offset:1024 lds
  buffer_load_dwordx4 v62, s[8:11], s54 offen offset:2048 lds
  buffer_load_dwordx4 v63, s[8:11], s54 offen offset:3072 lds
  s_add_u32 m0, s45, 4096
  s_add_u32 s54, s21, 4096
  buffer_load_dwordx4 v62, s[8:11], s54 offen offset:0 lds
  buffer_load_dwordx4 v63, s[8:11], s54 offen offset:1024 lds
  buffer_load_dwordx4 v62, s[8:11], s54 offen offset:2048 lds
  buffer_load_dwordx4 v63, s[8:11], s54 offen offset:3072 lds
  s_waitcnt vmcnt(0) lgkmcnt(0)
  ds_read_b128 a[96:99], v16 offset:0
  ds_read_b128 a[100:103], v17 offset:0
  ds_read_b128 a[104:107], v18 offset:0
  ds_read_b128 a[108:111], v19 offset:0
  ds_read_b128 a[112:115], v16 offset:4096
  ds_read_b128 a[116:119], v17 offset:4096
  ds_read_b128 a[120:123], v18 offset:4096
  ds_read_b128 a[124:127], v19 offset:4096
  s_waitcnt vmcnt(0) lgkmcnt(0)
  v_mfma_f32_16x16x32_bf16 v[96:99], a[96:99], a[0:3], 0
  v_mfma_f32_16x16x32_bf16 v[96:99], a[100:103], a[4:7], v[96:99]
  v_mfma_f32_16x16x32_bf16 v[96:99], a[104:107], a[8:11], v[96:99]
  v_mfma_f32_16x16x32_bf16 v[96:99], a[108:111], a[12:15], v[96:99]
  v_mfma_f32_16x16x32_bf16 v[104:107], a[108:111], a[28:31], 0
  v_mfma_f32_16x16x32_bf16 v[104:107], a[104:107], a[24:27], v[104:107]
  v_mfma_f32_16x16x32_bf16 v[104:107], a[100:103], a[20:23], v[104:107]
  v_mfma_f32_16x16x32_bf16 v[104:107], a[96:99], a[16:19], v[104:107]
  v_mfma_f32_16x16x32_bf16 v[108:111], a[112:115], a[16:19], 0
  v_mfma_f32_16x16x32_bf16 v[108:111], a[116:119], a[20:23], v[108:111]
  v_mfma_f32_16x16x32_bf16 v[108:111], a[120:123], a[24:27], v[108:111]
  v_mfma_f32_16x16x32_bf16 v[108:111], a[124:127], a[28:31], v[108:111]
  v_mfma_f32_16x16x32_bf16 v[100:103], a[124:127], a[12:15], 0
  v_mfma_f32_16x16x32_bf16 v[100:103], a[120:123], a[8:11], v[100:103]
  v_mfma_f32_16x16x32_bf16 v[100:103], a[116:119], a[4:7], v[100:103]
  v_mfma_f32_16x16x32_bf16 v[100:103], a[112:115], a[0:3], v[100:103]
  v_mfma_f32_16x16x32_bf16 v[112:115], a[96:99], a[32:35], 0
  v_mfma_f32_16x16x32_bf16 v[112:115], a[100:103], a[36:39], v[112:115]
  v_mfma_f32_16x16x32_bf16 v[112:115], a[104:107], a[40:43], v[112:115]
  v_mfma_f32_16x16x32_bf16 v[112:115], a[108:111], a[44:47], v[112:115]
  v_mfma_f32_16x16x32_bf16 v[120:123], a[108:111], a[60:63], 0
  v_mfma_f32_16x16x32_bf16 v[120:123], a[104:107], a[56:59], v[120:123]
  v_mfma_f32_16x16x32_bf16 v[120:123], a[100:103], a[52:55], v[120:123]
  v_mfma_f32_16x16x32_bf16 v[120:123], a[96:99], a[48:51], v[120:123]
  v_mfma_f32_16x16x32_bf16 v[124:127], a[112:115], a[48:51], 0
  v_mfma_f32_16x16x32_bf16 v[124:127], a[116:119], a[52:55], v[124:127]
  v_mfma_f32_16x16x32_bf16 v[124:127], a[120:123], a[56:59], v[124:127]
  v_mfma_f32_16x16x32_bf16 v[124:127], a[124:127], a[60:63], v[124:127]
  v_mfma_f32_16x16x32_bf16 v[116:119], a[124:127], a[44:47], 0
  v_mfma_f32_16x16x32_bf16 v[116:119], a[120:123], a[40:43], v[116:119]
  v_mfma_f32_16x16x32_bf16 v[116:119], a[116:119], a[36:39], v[116:119]
  v_mfma_f32_16x16x32_bf16 v[116:119], a[112:115], a[32:35], v[116:119]
  s_nop 7
  s_nop 3
  v_max3_f32 v50, v96, v97, v50
  v_max3_f32 v50, v98, v99, v50
  v_max3_f32 v50, v100, v101, v50
  v_max3_f32 v50, v102, v103, v50
  v_max3_f32 v51, v104, v105, v51
  v_max3_f32 v51, v106, v107, v51
  v_max3_f32 v51, v108, v109, v51
  v_max3_f32 v51, v110, v111, v51
  v_max3_f32 v52, v112, v113, v52
  v_max3_f32 v52, v114, v115, v52
  v_max3_f32 v52, v116, v117, v52
  v_max3_f32 v52, v118, v119, v52
  v_max3_f32 v53, v120, v121, v53
  v_max3_f32 v53, v122, v123, v53
  v_max3_f32 v53, v124, v125, v53
  v_max3_f32 v53, v126, v127, v53
  s_add_u32 s21, s21, 8192
  s_cmp_lt_u32 s21, s22
  s_cbranch_scc1 L_slow_p1
  v_mov_b32 v54, v50
  v_mov_b32 v55, v51
  v_mov_b32 v56, v52
  v_mov_b32 v57, v53
  s_nop 1
  v_permlane32_swap_b32 v54, v50
  v_permlane32_swap_b32 v55, v51
  v_permlane32_swap_b32 v56, v52
  v_permlane32_swap_b32 v57, v53
  s_nop 1
  v_max_f32 v50, v50, v54
  v_max_f32 v51, v51, v55
  v_max_f32 v52, v52, v56
  v_max_f32 v53, v53, v57
  v_mov_b32 v54, v50
  v_mov_b32 v55, v51
  v_mov_b32 v56, v52
  v_mov_b32 v57, v53
  s_nop 1
  v_permlane16_swap_b32 v54, v50
  v_permlane16_swap_b32 v55, v51
  v_permlane16_swap_b32 v56, v52
  v_permlane16_swap_b32 v57, v53
  s_nop 1
  v_max_f32 v50, v50, v54
  v_max_f32 v51, v51, v55
  v_max_f32 v52, v52, v56
  v_max_f32 v53, v53, v57
  v_mul_f32 v54, s27, v50
  v_mul_f32 v55, s27, v51
  v_mul_f32 v56, s27, v52
  v_mul_f32 v57, s27, v53
  v_mov_b32 v128, 0
  v_mov_b32 v129, 0
  v_mov_b32 v130, 0
  v_mov_b32 v131, 0
  v_mov_b32 v132, 0
  v_mov_b32 v133, 0
  v_mov_b32 v134, 0
  v_mov_b32 v135, 0
  v_mov_b32 v136, 0
  v_mov_b32 v137, 0
  v_mov_b32 v138, 0
  v_mov_b32 v139, 0
  v_mov_b32 v140, 0
  v_mov_b32 v141, 0
  v_mov_b32 v142, 0
  v_mov_b32 v143, 0
  v_mov_b32 v144, 0
  v_mov_b32 v145, 0
  v_mov_b32 v146, 0
  v_mov_b32 v147, 0
  v_mov_b32 v148, 0
  v_mov_b32 v149, 0
  v_mov_b32 v150, 0
  v_mov_b32 v151, 0
  v_mov_b32 v152, 0
  v_mov_b32 v153, 0
  v_mov_b32 v154, 0
  v_mov_b32 v155, 0
  v_mov_b32 v156, 0
  v_mov_b32 v157, 0
  v_mov_b32 v158, 0
  v_mov_b32 v159, 0
  v_mov_b32 v160, 0
  v_mov_b32 v161, 0
  v_mov_b32 v162, 0
  v_mov_b32 v163, 0
  v_mov_b32 v164, 0
  v_mov_b32 v165, 0
  v_mov_b32 v166, 0
  v_mov_b32 v167, 0
  v_mov_b32 v168, 0
  v_mov_b32 v169, 0
  v_mov_b32 v170, 0
  v_mov_b32 v171, 0
  v_mov_b32 v172, 0
  v_mov_b32 v173, 0
  v_mov_b32 v174, 0
  v_mov_b32 v175, 0
  v_mov_b32 v176, 0
  v_mov_b32 v177, 0
  v_mov_b32 v178, 0
  v_mov_b32 v179, 0
  v_mov_b32 v180, 0
  v_mov_b32 v181, 0
  v_mov_b32 v182, 0
  v_mov_b32 v183, 0
  v_mov_b32 v184, 0
  v_mov_b32 v185, 0
  v_mov_b32 v186, 0
  v_mov_b32 v187, 0
  v_mov_b32 v188, 0
  v_mov_b32 v189, 0
  v_mov_b32 v190, 0
  v_mov_b32 v191, 0
  v_mov_b32 v192, 0
  v_mov_b32 v193, 0
  v_mov_b32 v194, 0
  v_mov_b32 v195, 0
  v_mov_b32 v196, 0
  v_mov_b32 v197, 0
  v_mov_b32 v198, 0
  v_mov_b32 v199, 0
  v_mov_b32 v200, 0
  v_mov_b32 v201, 0
  v_mov_b32 v202, 0
  v_mov_b32 v203, 0
  v_mov_b32 v204, 0
  v_mov_b32 v205, 0
  v_mov_b32 v206, 0
  v_mov_b32 v207, 0
  v_mov_b32 v208, 0
  v_mov_b32 v209, 0
  v_mov_b32 v210, 0
  v_mov_b32 v211, 0
  v_mov_b32 v212, 0
  v_mov_b32 v213, 0
  v_mov_b32 v214, 0
  v_mov_b32 v215, 0
  v_mov_b32 v216, 0
  v_mov_b32 v217, 0
  v_mov_b32 v218, 0
  v_mov_b32 v219, 0
  v_mov_b32 v220, 0
  v_mov_b32 v221, 0
  v_mov_b32 v222, 0
  v_mov_b32 v223, 0
  v_mov_b32 v224, 0
  v_mov_b32 v225, 0
  v_mov_b32 v226, 0
  v_mov_b32 v227, 0
  v_mov_b32 v228, 0
  v_mov_b32 v229, 0
  v_mov_b32 v230, 0
  v_mov_b32 v231, 0
  v_mov_b32 v232, 0
  v_mov_b32 v233, 0
  v_mov_b32 v234, 0
  v_mov_b32 v235, 0
  v_mov_b32 v236, 0
  v_mov_b32 v237, 0
  v_mov_b32 v238, 0
  v_mov_b32 v239, 0
  v_mov_b32 v240, 0
  v_mov_b32 v241, 0
  v_mov_b32 v242, 0
  v_mov_b32 v243, 0
  v_mov_b32 v244, 0
  v_mov_b32 v245, 0
  v_mov_b32 v246, 0
  v_mov_b32 v247, 0
  v_mov_b32 v248, 0
  v_mov_b32 v249, 0
  v_mov_b32 v250, 0
  v_mov_b32 v251, 0
  v_mov_b32 v252, 0
  v_mov_b32 v253, 0
  v_mov_b32 v254, 0
  v_mov_b32 v255, 0
  v_accvgpr_write_b32 a224, 0
  v_accvgpr_write_b32 a225, 0
  v_accvgpr_write_b32 a226, 0
  v_accvgpr_write_b32 a227, 0
  v_accvgpr_write_b32 a228, 0
  v_accvgpr_write_b32 a229, 0
  v_accvgpr_write_b32 a230, 0
  v_accvgpr_write_b32 a231, 0
  v_accvgpr_write_b32 a232, 0
  v_accvgpr_write_b32 a233, 0
  v_accvgpr_write_b32 a234, 0
  v_accvgpr_write_b32 a235, 0
  v_accvgpr_write_b32 a236, 0
  v_accvgpr_write_b32 a237, 0
  v_accvgpr_write_b32 a238, 0
  v_accvgpr_write_b32 a239, 0
  s_mov_b32 s21, s47
L_slow_p2:
  s_add_u32 m0, s45, 0
  s_add_u32 s54, s21, 0
  buffer_load_dwordx4 v62, s[8:11], s54 offen offset:0 lds
  buffer_load_dwordx4 v63, s[8:11], s54 offen offset:1024 lds
  buffer_load_dwordx4 v62, s[8:11], s54 offen offset:2048 lds
  buffer_load_dwordx4 v63, s[8:11], s54 offen offset:3072 lds
  s_add_u32 m0, s45, 4096
  s_add_u32 s54, s21, 4096
  buffer_load_dwordx4 v62, s[8:11], s54 offen offset:0 lds
  buffer_load_dwordx4 v63, s[8:11], s54 offen offset:1024 lds
  buffer_load_dwordx4 v62, s[8:11], s54 offen offset:2048 lds
  buffer_load_dwordx4 v63, s[8:11], s54 offen offset:3072 lds
  s_add_u32 m0, s46, 0
  s_add_u32 s54, s21, 0
  buffer_load_dwordx4 v62, s[12:15], s54 offen offset:0 lds
  buffer_load_dwordx4 v63, s[12:15], s54 offen offset:1024 lds
  buffer_load_dwordx4 v62, s[12:15], s54 offen offset:2048 lds
  buffer_load_dwordx4 v63, s[12:15], s54 offen offset:3072 lds
  s_add_u32 m0, s46, 4096
  s_add_u32 s54, s21, 4096
  buffer_load_dwordx4 v62, s[12:15], s54 offen offset:0 lds
  buffer_load_dwordx4 v63, s[12:15], s54 offen offset:1024 lds
  buffer_load_dwordx4 v62, s[12:15], s54 offen offset:2048 lds
  buffer_load_dwordx4 v63, s[12:15], s54 offen offset:3072 lds
  s_waitcnt vmcnt(0) lgkmcnt(0)
  ds_read_b128 a[96:99], v16 offset:0
  ds_read_b128 a[100:103], v17 offset:0
  ds_read_b128 a[104:107], v18 offset:0
  ds_read_b128 a[108:111], v19 offset:0
  ds_read_b128 a[112:115], v16 offset:4096
  ds_read_b128 a[116:119], v17 offset:4096
  ds_read_b128 a[120:123], v18 offset:4096
  ds_read_b128 a[124:127], v19 offset:4096
  s_waitcnt vmcnt(0) lgkmcnt(0)
  v_mfma_f32_16x16x32_bf16 v[96:99], a[96:99], a[0:3], 0
  v_mfma_f32_16x16x32_bf16 v[96:99], a[100:103], a[4:7], v[96:99]
  v_mfma_f32_16x16x32_bf16 v[96:99], a[104:107], a[8:11], v[96:99]
  v_mfma_f32_16x16x32_bf16 v[96:99], a[108:111], a[12:15], v[96:99]
  v_mfma_f32_16x16x32_bf16 v[104:107], a[108:111], a[28:31], 0
  v_mfma_f32_16x16x32_bf16 v[104:107], a[104:107], a[24:27], v[104:107]
  v_mfma_f32_16x16x32_bf16 v[104:107], a[100:103], a[20:23], v[104:107]
  v_mfma_f32_16x16x32_bf16 v[104:107], a[96:99], a[16:19], v[104:107]
  v_mfma_f32_16x16x32_bf16 v[108:111], a[112:115], a[16:19], 0
  v_mfma_f32_16x16x32_bf16 v[108:111], a[116:119], a[20:23], v[108:111]
  v_mfma_f32_16x16x32_bf16 v[108:111], a[120:123], a[24:27], v[108:111]
  v_mfma_f32_16x16x32_bf16 v[108:111], a[124:127], a[28:31], v[108:111]
  v_mfma_f32_16x16x32_bf16 v[100:103], a[124:127], a[12:15], 0
  v_mfma_f32_16x16x32_bf16 v[100:103], a[120:123], a[8:11], v[100:103]
  v_mfma_f32_16x16x32_bf16 v[100:103], a[116:119], a[4:7], v[100:103]
  v_mfma_f32_16x16x32_bf16 v[100:103], a[112:115], a[0:3], v[100:103]
  v_mfma_f32_16x16x32_bf16 v[112:115], a[96:99], a[32:35], 0
  v_mfma_f32_16x16x32_bf16 v[112:115], a[100:103], a[36:39], v[112:115]
  v_mfma_f32_16x16x32_bf16 v[112:115], a[104:107], a[40:43], v[112:115]
  v_mfma_f32_16x16x32_bf16 v[112:115], a[108:111], a[44:47], v[112:115]
  v_mfma_f32_16x16x32_bf16 v[120:123], a[108:111], a[60:63], 0
  v_mfma_f32_16x16x32_bf16 v[120:123], a[104:107], a[56:59], v[120:123]
  v_mfma_f32_16x16x32_bf16 v[120:123], a[100:103], a[52:55], v[120:123]
  v_mfma_f32_16x16x32_bf16 v[120:123], a[96:99], a[48:51], v[120:123]
  v_mfma_f32_16x16x32_bf16 v[124:127], a[112:115], a[48:51], 0
  v_mfma_f32_16x16x32_bf16 v[124:127], a[116:119], a[52:55], v[124:127]
  v_mfma_f32_16x16x32_bf16 v[124:127], a[120:123], a[56:59], v[124:127]
  v_mfma_f32_16x16x32_bf16 v[124:127], a[124:127], a[60:63], v[124:127]
  v_mfma_f32_16x16x32_bf16 v[116:119], a[124:127], a[44:47], 0
  v_mfma_f32_16x16x32_bf16 v[116:119], a[120:123], a[40:43], v[116:119]
  v_mfma_f32_16x16x32_bf16 v[116:119], a[116:119], a[36:39], v[116:119]
  v_mfma_f32_16x16x32_bf16 v[116:119], a[112:115], a[32:35], v[116:119]
  s_nop 7
  s_nop 3
  ds_read_b64_tr_b16 a[128:129], v20 offset:0
  ds_read_b64_tr_b16 a[130:131], v20 offset:4096
  ds_read_b64_tr_b16 a[132:133], v21 offset:0
  ds_read_b64_tr_b16 a[134:135], v21 offset:4096
  ds_read_b64_tr_b16 a[136:137], v22 offset:0
  ds_read_b64_tr_b16 a[138:139], v22 offset:4096
  ds_read_b64_tr_b16 a[140:141], v23 offset:0
  ds_read_b64_tr_b16 a[142:143], v23 offset:4096
  v_fma_f32 v96, v96, s27, -v54
  v_fma_f32 v97, v97, s27, -v54
  v_fma_f32 v98, v98, s27, -v54
  v_fma_f32 v99, v99, s27, -v54
  v_fma_f32 v100, v100, s27, -v54
  v_fma_f32 v101, v101, s27, -v54
  v_fma_f32 v102, v102, s27, -v54
  v_fma_f32 v103, v103, s27, -v54
  v_exp_f32 v96, v96
  v_exp_f32 v97, v97
  v_exp_f32 v98, v98
  v_exp_f32 v99, v99
  v_exp_f32 v100, v100
  v_exp_f32 v101, v101
  v_exp_f32 v102, v102
  v_exp_f32 v103, v103
  s_nop 0
  v_cvt_pk_bf16_f32 v80, v96, v97
  v_cvt_pk_bf16_f32 v81, v98, v99
  v_cvt_pk_bf16_f32 v82, v100, v101
  v_cvt_pk_bf16_f32 v83, v102, v103
  v_fma_f32 v104, v104, s27, -v55
  v_fma_f32 v105, v105, s27, -v55
  v_fma_f32 v106, v106, s27, -v55
  v_fma_f32 v107, v107, s27, -v55
  v_fma_f32 v108, v108, s27, -v55
  v_fma_f32 v109, v109, s27, -v55
  v_fma_f32 v110, v110, s27, -v55
  v_fma_f32 v111, v111, s27, -v55
  v_exp_f32 v104, v104
  v_exp_f32 v105, v105
  v_exp_f32 v106, v106
  v_exp_f32 v107, v107
  v_exp_f32 v108, v108
  v_exp_f32 v109, v109
  v_exp_f32 v110, v110
  v_exp_f32 v111, v111
  s_nop 0
  v_cvt_pk_bf16_f32 v84, v104, v105
  v_cvt_pk_bf16_f32 v85, v106, v107
  v_cvt_pk_bf16_f32 v86, v108, v109
  v_cvt_pk_bf16_f32 v87, v110, v111
  v_fma_f32 v112, v112, s27, -v56
  v_fma_f32 v113, v113, s27, -v56
  v_fma_f32 v114, v114, s27, -v56
  v_fma_f32 v115, v115, s27, -v56
  v_fma_f32 v116, v116, s27, -v56
  v_fma_f32 v117, v117, s27, -v56
  v_fma_f32 v118, v118, s27, -v56
  v_fma_f32 v119, v119, s27, -v56
  v_exp_f32 v112, v112
  v_exp_f32 v113, v113
  v_exp_f32 v114, v114
  v_exp_f32 v115, v115
  v_exp_f32 v116, v116
  v_exp_f32 v117, v117
  v_exp_f32 v118, v118
  v_exp_f32 v119, v119
  s_nop 0
  v_cvt_pk_bf16_f32 v88, v112, v113
  v_cvt_pk_bf16_f32 v89, v114, v115
  v_cvt_pk_bf16_f32 v90, v116, v117
  v_cvt_pk_bf16_f32 v91, v118, v119
  v_fma_f32 v120, v120, s27, -v57
  v_fma_f32 v121, v121, s27, -v57
  v_fma_f32 v122, v122, s27, -v57
  v_fma_f32 v123, v123, s27, -v57
  v_fma_f32 v124, v124, s27, -v57
  v_fma_f32 v125, v125, s27, -v57
  v_fma_f32 v126, v126, s27, -v57
  v_fma_f32 v127, v127, s27, -v57
  v_exp_f32 v120, v120
  v_exp_f32 v121, v121
  v_exp_f32 v122, v122
  v_exp_f32 v123, v123
  v_exp_f32 v124, v124
  v_exp_f32 v125, v125
  v_exp_f32 v126, v126
  v_exp_f32 v127, v127
  s_nop 0
  v_cvt_pk_bf16_f32 v92, v120, v121
  v_cvt_pk_bf16_f32 v93, v122, v123
  v_cvt_pk_bf16_f32 v94, v124, v125
  v_cvt_pk_bf16_f32 v95, v126, v127
  ds_read_b64_tr_b16 a[144:145], v24 offset:0
  ds_read_b64_tr_b16 a[146:147], v24 offset:4096
  ds_read_b64_tr_b16 a[148:149], v25 offset:0
  ds_read_b64_tr_b16 a[150:151], v25 offset:4096
  ds_read_b64_tr_b16 a[152:153], v26 offset:0
  ds_read_b64_tr_b16 a[154:155], v26 offset:4096
  ds_read_b64_tr_b16 a[156:157], v27 offset:0
  ds_read_b64_tr_b16 a[158:159], v27 offset:4096
  s_waitcnt vmcnt(0) lgkmcnt(0)
  v_mfma_f32_16x16x32_bf16 v[128:131], a[128:131], v[80:83], v[128:131]
  v_mfma_f32_16x16x32_bf16 v[160:163], a[128:131], v[84:87], v[160:163]
  v_mfma_f32_16x16x32_bf16 v[132:135], a[132:135], v[80:83], v[132:135]
  v_mfma_f32_16x16x32_bf16 v[164:167], a[132:135], v[84:87], v[164:167]
  v_mfma_f32_16x16x32_bf16 v[136:139], a[136:139], v[80:83], v[136:139]
  v_mfma_f32_16x16x32_bf16 v[168:171], a[136:139], v[84:87], v[168:171]
  v_mfma_f32_16x16x32_bf16 a[224:227], a[240:243], v[80:83], a[224:227]
  v_mfma_f32_16x16x32_bf16 v[140:143], a[140:143], v[80:83], v[140:143]
  v_mfma_f32_16x16x32_bf16 v[172:175], a[140:143], v[84:87], v[172:175]
  v_mfma_f32_16x16x32_bf16 v[144:147], a[144:147], v[80:83], v[144:147]
  v_mfma_f32_16x16x32_bf16 v[176:179], a[144:147], v[84:87], v[176:179]
  v_mfma_f32_16x16x32_bf16 v[148:151], a[148:151], v[80:83], v[148:151]
  v_mfma_f32_16x16x32_bf16 v[180:183], a[148:151], v[84:87], v[180:183]
  v_mfma_f32_16x16x32_bf16 a[228:231], a[240:243], v[84:87], a[228:231]
  v_mfma_f32_16x16x32_bf16 v[152:155], a[152:155], v[80:83], v[152:155]
  v_mfma_f32_16x16x32_bf16 v[184:187], a[152:155], v[84:87], v[184:187]
  v_mfma_f32_16x16x32_bf16 v[156:159], a[156:159], v[80:83], v[156:159]
  v_mfma_f32_16x16x32_bf16 v[188:191], a[156:159], v[84:87], v[188:191]
  v_mfma_f32_16x16x32_bf16 v[192:195], a[128:131], v[88:91], v[192:195]
  v_mfma_f32_16x16x32_bf16 v[224:227], a[128:131], v[92:95], v[224:227]
  v_mfma_f32_16x16x32_bf16 v[196:199], a[132:135], v[88:91], v[196:199]
  v_mfma_f32_16x16x32_bf16 v[228:231], a[132:135], v[92:95], v[228:231]
  v_mfma_f32_16x16x32_bf16 v[200:203], a[136:139], v[88:91], v[200:203]
  v_mfma_f32_16x16x32_bf16 v[232:235], a[136:139], v[92:95], v[232:235]
  v_mfma_f32_16x16x32_bf16 a[232:235], a[240:243], v[88:91], a[232:235]
  v_mfma_f32_16x16x32_bf16 v[204:207], a[140:143], v[88:91], v[204:207]
  v_mfma_f32_16x16x32_bf16 v[236:239], a[140:143], v[92:95], v[236:239]
  v_mfma_f32_16x16x32_bf16 v[208:211], a[144:147], v[88:91], v[208:211]
  v_mfma_f32_16x16x32_bf16 v[240:243], a[144:147], v[92:95], v[240:243]
  v_mfma_f32_16x16x32_bf16 v[212:215], a[148:151], v[88:91], v[212:215]
  v_mfma_f32_16x16x32_bf16 v[244:247], a[148:151], v[92:95], v[244:247]
  v_mfma_f32_16x16x32_bf16 a[236:239], a[240:243], v[92:95], a[236:239]
  v_mfma_f32_16x16x32_bf16 v[216:219], a[152:155], v[88:91], v[216:219]
  v_mfma_f32_16x16x32_bf16 v[248:251], a[152:155], v[92:95], v[248:251]
  v_mfma_f32_16x16x32_bf16 v[220:223], a[156:159], v[88:91], v[220:223]
  v_mfma_f32_16x16x32_bf16 v[252:255], a[156:159], v[92:95], v[252:255]
  s_add_u32 s21, s21, 8192
  s_cmp_lt_u32 s21, s22
  s_cbranch_scc1 L_slow_p2
  s_nop 7
  s_nop 3
  v_accvgpr_read_b32 v42, a224
  v_accvgpr_read_b32 v43, a228
  v_rcp_f32 v44, v42
  v_rcp_f32 v46, v43
  s_nop 0
  v_pk_mul_f32 v[128:129], v[128:129], v[44:45] op_sel_hi:[1,0]
  v_pk_mul_f32 v[130:131], v[130:131], v[44:45] op_sel_hi:[1,0]
  v_pk_mul_f32 v[132:133], v[132:133], v[44:45] op_sel_hi:[1,0]
  v_pk_mul_f32 v[134:135], v[134:135], v[44:45] op_sel_hi:[1,0]
  v_pk_mul_f32 v[136:137], v[136:137], v[44:45] op_sel_hi:[1,0]
  v_pk_mul_f32 v[138:139], v[138:139], v[44:45] op_sel_hi:[1,0]
  v_pk_mul_f32 v[140:141], v[140:141], v[44:45] op_sel_hi:[1,0]
  v_pk_mul_f32 v[142:143], v[142:143], v[44:45] op_sel_hi:[1,0]
  v_pk_mul_f32 v[144:145], v[144:145], v[44:45] op_sel_hi:[1,0]
  v_pk_mul_f32 v[146:147], v[146:147], v[44:45] op_sel_hi:[1,0]
  v_pk_mul_f32 v[148:149], v[148:149], v[44:45] op_sel_hi:[1,0]
  v_pk_mul_f32 v[150:151], v[150:151], v[44:45] op_sel_hi:[1,0]
  v_pk_mul_f32 v[152:153], v[152:153], v[44:45] op_sel_hi:[1,0]
  v_pk_mul_f32 v[154:155], v[154:155], v[44:45] op_sel_hi:[1,0]
  v_pk_mul_f32 v[156:157], v[156:157], v[44:45] op_sel_hi:[1,0]
  v_pk_mul_f32 v[158:159], v[158:159], v[44:45] op_sel_hi:[1,0]
  v_pk_mul_f32 v[160:161], v[160:161], v[46:47] op_sel_hi:[1,0]
  v_pk_mul_f32 v[162:163], v[162:163], v[46:47] op_sel_hi:[1,0]
  v_pk_mul_f32 v[164:165], v[164:165], v[46:47] op_sel_hi:[1,0]
  v_pk_mul_f32 v[166:167], v[166:167], v[46:47] op_sel_hi:[1,0]
  v_pk_mul_f32 v[168:169], v[168:169], v[46:47] op_sel_hi:[1,0]
  v_pk_mul_f32 v[170:171], v[170:171], v[46:47] op_sel_hi:[1,0]
  v_pk_mul_f32 v[172:173], v[172:173], v[46:47] op_sel_hi:[1,0]
  v_pk_mul_f32 v[174:175], v[174:175], v[46:47] op_sel_hi:[1,0]
  v_pk_mul_f32 v[176:177], v[176:177], v[46:47] op_sel_hi:[1,0]
  v_pk_mul_f32 v[178:179], v[178:179], v[46:47] op_sel_hi:[1,0]
  v_pk_mul_f32 v[180:181], v[180:181], v[46:47] op_sel_hi:[1,0]
  v_pk_mul_f32 v[182:183], v[182:183], v[46:47] op_sel_hi:[1,0]
  v_pk_mul_f32 v[184:185], v[184:185], v[46:47] op_sel_hi:[1,0]
  v_pk_mul_f32 v[186:187], v[186:187], v[46:47] op_sel_hi:[1,0]
  v_pk_mul_f32 v[188:189], v[188:189], v[46:47] op_sel_hi:[1,0]
  v_pk_mul_f32 v[190:191], v[190:191], v[46:47] op_sel_hi:[1,0]
  v_cvt_pk_bf16_f32 v128, v128, v129
  v_cvt_pk_bf16_f32 v129, v130, v131
  v_cvt_pk_bf16_f32 v130, v132, v133
  v_cvt_pk_bf16_f32 v131, v134, v135
  v_cvt_pk_bf16_f32 v136, v136, v137
  v_cvt_pk_bf16_f32 v137, v138, v139
  v_cvt_pk_bf16_f32 v138, v140, v141
  v_cvt_pk_bf16_f32 v139, v142, v143
  v_cvt_pk_bf16_f32 v144, v144, v145
  v_cvt_pk_bf16_f32 v145, v146, v147
  v_cvt_pk_bf16_f32 v146, v148, v149
  v_cvt_pk_bf16_f32 v147, v150, v151
  v_cvt_pk_bf16_f32 v152, v152, v153
  v_cvt_pk_bf16_f32 v153, v154, v155
  v_cvt_pk_bf16_f32 v154, v156, v157
  v_cvt_pk_bf16_f32 v155, v158, v159
  v_cvt_pk_bf16_f32 v160, v160, v161
  v_cvt_pk_bf16_f32 v161, v162, v163
  v_cvt_pk_bf16_f32 v162, v164, v165
  v_cvt_pk_bf16_f32 v163, v166, v167
  v_cvt_pk_bf16_f32 v168, v168, v169
  v_cvt_pk_bf16_f32 v169, v170, v171
  v_cvt_pk_bf16_f32 v170, v172, v173
  v_cvt_pk_bf16_f32 v171, v174, v175
  v_cvt_pk_bf16_f32 v176, v176, v177
  v_cvt_pk_bf16_f32 v177, v178, v179
  v_cvt_pk_bf16_f32 v178, v180, v181
  v_cvt_pk_bf16_f32 v179, v182, v183
  v_cvt_pk_bf16_f32 v184, v184, v185
  v_cvt_pk_bf16_f32 v185, v186, v187
  v_cvt_pk_bf16_f32 v186, v188, v189
  v_cvt_pk_bf16_f32 v187, v190, v191
  ds_write_b128 v34, v[128:131] offset:0
  ds_write_b128 v35, v[136:139] offset:0
  ds_write_b128 v34, v[144:147] offset:128
  ds_write_b128 v35, v[152:155] offset:128
  ds_write_b128 v34, v[160:163] offset:4096
  ds_write_b128 v35, v[168:171] offset:4096
  ds_write_b128 v34, v[176:179] offset:4224
  ds_write_b128 v35, v[184:187] offset:4224
  ds_read_b64 a[160:161], v8 offset:0
  ds_read_b64 a[162:163], v9 offset:0
  ds_read_b64 a[164:165], v10 offset:1024
  ds_read_b64 a[166:167], v11 offset:1024
  ds_read_b64 a[168:169], v8 offset:2048
  ds_read_b64 a[170:171], v9 offset:2048
  ds_read_b64 a[172:173], v10 offset:3072
  ds_read_b64 a[174:175], v11 offset:3072
  ds_read_b64 a[176:177], v8 offset:4096
  ds_read_b64 a[178:179], v9 offset:4096
  ds_read_b64 a[180:181], v10 offset:5120
  ds_read_b64 a[182:183], v11 offset:5120
  ds_read_b64 a[184:185], v8 offset:6144
  ds_read_b64 a[186:187], v9 offset:6144
  ds_read_b64 a[188:189], v10 offset:7168
  ds_read_b64 a[190:191], v11 offset:7168
  s_waitcnt vmcnt(0) lgkmcnt(0)
  buffer_store_dwordx4 a[160:163], v40, s[16:19], s72 offen offset:0 nt
  buffer_store_dwordx4 a[164:167], v40, s[16:19], s72 offen offset:1024 nt
  buffer_store_dwordx4 a[168:171], v40, s[16:19], s73 offen offset:0 nt
  buffer_store_dwordx4 a[172:175], v40, s[16:19], s73 offen offset:1024 nt
  buffer_store_dwordx4 a[176:179], v40, s[16:19], s74 offen offset:0 nt
  buffer_store_dwordx4 a[180:183], v40, s[16:19], s74 offen offset:1024 nt
  buffer_store_dwordx4 a[184:187], v40, s[16:19], s75 offen offset:0 nt
  buffer_store_dwordx4 a[188:191], v40, s[16:19], s75 offen offset:1024 nt
  s_waitcnt vmcnt(0) lgkmcnt(0)
  v_accvgpr_read_b32 v42, a232
  v_accvgpr_read_b32 v43, a236
  v_rcp_f32 v44, v42
  v_rcp_f32 v46, v43
  s_nop 0
  v_pk_mul_f32 v[192:193], v[192:193], v[44:45] op_sel_hi:[1,0]
  v_pk_mul_f32 v[194:195], v[194:195], v[44:45] op_sel_hi:[1,0]
  v_pk_mul_f32 v[196:197], v[196:197], v[44:45] op_sel_hi:[1,0]
  v_pk_mul_f32 v[198:199], v[198:199], v[44:45] op_sel_hi:[1,0]
  v_pk_mul_f32 v[200:201], v[200:201], v[44:45] op_sel_hi:[1,0]
  v_pk_mul_f32 v[202:203], v[202:203], v[44:45] op_sel_hi:[1,0]
  v_pk_mul_f32 v[204:205], v[204:205], v[44:45] op_sel_hi:[1,0]
  v_pk_mul_f32 v[206:207], v[206:207], v[44:45] op_sel_hi:[1,0]
  v_pk_mul_f32 v[208:209], v[208:209], v[44:45] op_sel_hi:[1,0]
  v_pk_mul_f32 v[210:211], v[210:211], v[44:45] op_sel_hi:[1,0]
  v_pk_mul_f32 v[212:213], v[212:213], v[44:45] op_sel_hi:[1,0]
  v_pk_mul_f32 v[214:215], v[214:215], v[44:45] op_sel_hi:[1,0]
  v_pk_mul_f32 v[216:217], v[216:217], v[44:45] op_sel_hi:[1,0]
  v_pk_mul_f32 v[218:219], v[218:219], v[44:45] op_sel_hi:[1,0]
  v_pk_mul_f32 v[220:221], v[220:221], v[44:45] op_sel_hi:[1,0]
  v_pk_mul_f32 v[222:223], v[222:223], v[44:45] op_sel_hi:[1,0]
  v_pk_mul_f32 v[224:225], v[224:225], v[46:47] op_sel_hi:[1,0]
  v_pk_mul_f32 v[226:227], v[226:227], v[46:47] op_sel_hi:[1,0]
  v_pk_mul_f32 v[228:229], v[228:229], v[46:47] op_sel_hi:[1,0]
  v_pk_mul_f32 v[230:231], v[230:231], v[46:47] op_sel_hi:[1,0]
  v_pk_mul_f32 v[232:233], v[232:233], v[46:47] op_sel_hi:[1,0]
  v_pk_mul_f32 v[234:235], v[234:235], v[46:47] op_sel_hi:[1,0]
  v_pk_mul_f32 v[236:237], v[236:237], v[46:47] op_sel_hi:[1,0]
  v_pk_mul_f32 v[238:239], v[238:239], v[46:47] op_sel_hi:[1,0]
  v_pk_mul_f32 v[240:241], v[240:241], v[46:47] op_sel_hi:[1,0]
  v_pk_mul_f32 v[242:243], v[242:243], v[46:47] op_sel_hi:[1,0]
  v_pk_mul_f32 v[244:245], v[244:245], v[46:47] op_sel_hi:[1,0]
  v_pk_mul_f32 v[246:247], v[246:247], v[46:47] op_sel_hi:[1,0]
  v_pk_mul_f32 v[248:249], v[248:249], v[46:47] op_sel_hi:[1,0]
  v_pk_mul_f32 v[250:251], v[250:251], v[46:47] op_sel_hi:[1,0]
  v_pk_mul_f32 v[252:253], v[252:253], v[46:47] op_sel_hi:[1,0]
  v_pk_mul_f32 v[254:255], v[254:255], v[46:47] op_sel_hi:[1,0]
  v_cvt_pk_bf16_f32 v192, v192, v193
  v_cvt_pk_bf16_f32 v193, v194, v195
  v_cvt_pk_bf16_f32 v194, v196, v197
  v_cvt_pk_bf16_f32 v195, v198, v199
  v_cvt_pk_bf16_f32 v200, v200, v201
  v_cvt_pk_bf16_f32 v201, v202, v203
  v_cvt_pk_bf16_f32 v202, v204, v205
  v_cvt_pk_bf16_f32 v203, v206, v207
  v_cvt_pk_bf16_f32 v208, v208, v209
  v_cvt_pk_bf16_f32 v209, v210, v211
  v_cvt_pk_bf16_f32 v210, v212, v213
  v_cvt_pk_bf16_f32 v211, v214, v215
  v_cvt_pk_bf16_f32 v216, v216, v217
  v_cvt_pk_bf16_f32 v217, v218, v219
  v_cvt_pk_bf16_f32 v218, v220, v221
  v_cvt_pk_bf16_f32 v219, v222, v223
  v_cvt_pk_bf16_f32 v224, v224, v225
  v_cvt_pk_bf16_f32 v225, v226, v227
  v_cvt_pk_bf16_f32 v226, v228, v229
  v_cvt_pk_bf16_f32 v227, v230, v231
  v_cvt_pk_bf16_f32 v232, v232, v233
  v_cvt_pk_bf16_f32 v233, v234, v235
  v_cvt_pk_bf16_f32 v234, v236, v237
  v_cvt_pk_bf16_f32 v235, v238, v239
  v_cvt_pk_bf16_f32 v240, v240, v241
  v_cvt_pk_bf16_f32 v241, v242, v243
  v_cvt_pk_bf16_f32 v242, v244, v245
  v_cvt_pk_bf16_f32 v243, v246, v247
  v_cvt_pk_bf16_f32 v248, v248, v249
  v_cvt_pk_bf16_f32 v249, v250, v251
  v_cvt_pk_bf16_f32 v250, v252, v253
  v_cvt_pk_bf16_f32 v251, v254, v255
  ds_write_b128 v34, v[192:195] offset:0
  ds_write_b128 v35, v[200:203] offset:0
  ds_write_b128 v34, v[208:211] offset:128
  ds_write_b128 v35, v[216:219] offset:128
  ds_write_b128 v34, v[224:227] offset:4096
  ds_write_b128 v35, v[232:235] offset:4096
  ds_write_b128 v34, v[240:243] offset:4224
  ds_write_b128 v35, v[248:251] offset:4224
  ds_read_b64 a[192:193], v8 offset:0
  ds_read_b64 a[194:195], v9 offset:0
  ds_read_b64 a[196:197], v10 offset:1024
  ds_read_b64 a[198:199], v11 offset:1024
  ds_read_b64 a[200:201], v8 offset:2048
  ds_read_b64 a[202:203], v9 offset:2048
  ds_read_b64 a[204:205], v10 offset:3072
  ds_read_b64 a[206:207], v11 offset:3072
  ds_read_b64 a[208:209], v8 offset:4096
  ds_read_b64 a[210:211], v9 offset:4096
  ds_read_b64 a[212:213], v10 offset:5120
  ds_read_b64 a[214:215], v11 offset:5120
  ds_read_b64 a[216:217], v8 offset:6144
  ds_read_b64 a[218:219], v9 offset:6144
  ds_read_b64 a[220:221], v10 offset:7168
  ds_read_b64 a[222:223], v11 offset:7168
  s_waitcnt vmcnt(0) lgkmcnt(0)
  buffer_store_dwordx4 a[192:195], v40, s[16:19], s76 offen offset:0 nt
  buffer_store_dwordx4 a[196:199], v40, s[16:19], s76 offen offset:1024 nt
  buffer_store_dwordx4 a[200:203], v40, s[16:19], s77 offen offset:0 nt
  buffer_store_dwordx4 a[204:207], v40, s[16:19], s77 offen offset:1024 nt
  buffer_store_dwordx4 a[208:211], v40, s[16:19], s78 offen offset:0 nt
  buffer_store_dwordx4 a[212:215], v40, s[16:19], s78 offen offset:1024 nt
  buffer_store_dwordx4 a[216:219], v40, s[16:19], s79 offen offset:0 nt
  buffer_store_dwordx4 a[220:223], v40, s[16:19], s79 offen offset:1024 nt
  s_waitcnt vmcnt(0) lgkmcnt(0)
L_slow_next:
  s_lshl_b32 s28, s28, 1
  s_and_b32 s28, s28, 15
  s_add_u32 s47, s47, 16777216
  s_add_u32 s25, s25, 16777216
  s_cmp_lg_u32 s28, 0
  s_cbranch_scc1 L_slow_unit
L_end:
  s_endpgm
.section .rodata,"a"
.p2align 6
.amdhsa_kernel standalone__mha_softmax__near_ridge_kernel
  .amdhsa_next_free_vgpr 512
  .amdhsa_next_free_sgpr 96
  .amdhsa_accum_offset 256
  .amdhsa_group_segment_fixed_size 0
  .amdhsa_kernarg_size 48
  .amdhsa_user_sgpr_count 2
  .amdhsa_user_sgpr_kernarg_segment_ptr 1
  .amdhsa_system_sgpr_workgroup_id_x 1
.end_amdhsa_kernel
```
